```python
import torch

def _softmax(x, axis=-1):
    return torch.softmax(x, dim=axis)
def _gelu(x):
    return torch.nn.functional.gelu(x, approximate="tanh")
def _silu(x):
    return torch.nn.functional.silu(x)
def _sigmoid(x):
    return torch.sigmoid(x)
def _layernorm(x, axis=-1, eps=1e-5):
    m = x.mean(dim=axis, keepdim=True)
    v = x.var(dim=axis, keepdim=True, unbiased=False)
    return (x - m) / torch.sqrt(v + eps)
def _scatter_add(tgt, idx, src, axis=0):
    return tgt.clone().index_add_(axis, idx, src)
def _segment_sum(src, seg, n):
    out = torch.zeros((n,) + src.shape[1:], dtype=src.dtype)
    return out.index_add_(0, seg, src)
def _pad(x, pw):
    flat = tuple(v for pair in reversed(pw) for v in pair)
    return torch.nn.functional.pad(x, flat)

kernel_name = 'recurrent_scan__spectral_gfnet__mixer_s_mlp__prompt'

def setup_inputs():

    _w = (lambda a: (lambda t: t.to(torch.bfloat16) if t.is_floating_point() else t)(torch.as_tensor(a)))
    def _A_setup():
        B, S, D = 1, 2048, 512
        Df = D // 2 + 1
        return {
            "x": _w((lambda *s: torch.randn(*s, dtype=torch.bfloat16) * 0.05)(B, S, D)),
            "w_r": _w((lambda *s: torch.randn(*s, dtype=torch.bfloat16) * 0.2)(S, Df) * 0.02),
            "w_i": _w((lambda *s: torch.randn(*s, dtype=torch.bfloat16) * 0.2)(S, Df) * 0.02),
        }
    _A_in = _A_setup()

    def _B_setup():
        B, S, D, F = 1, 2048, 512, 1792
        return {
            "x":  _w((lambda *s: torch.randn(*s, dtype=torch.bfloat16) * 0.05)(B, S, D)),
            "w1": _w((lambda *s: torch.randn(*s, dtype=torch.bfloat16) * 1.6)(D, D) * (D ** -0.5)),
            "w2": _w((lambda *s: torch.randn(*s, dtype=torch.bfloat16) * 1.6)(D, D) * (D ** -0.5)),
            "w3": _w((lambda *s: torch.randn(*s, dtype=torch.bfloat16) * 1.6)(D, F) * (D ** -0.5)),
            "w4": _w((lambda *s: torch.randn(*s, dtype=torch.bfloat16) * 1.6)(F, D) * (F ** -0.5)),
        }
    _B_in = _B_setup()

    return {
        "A_x": _A_in["x"],
        "A_w_r": _A_in["w_r"],
        "A_w_i": _A_in["w_i"],
        "B_x": _B_in["x"],
        "B_w1": _B_in["w1"],
        "B_w2": _B_in["w2"],
        "B_w3": _B_in["w3"],
        "B_w4": _B_in["w4"],
    }

def reference(A_x, A_w_r, A_w_i, B_x, B_w1, B_w2, B_w3, B_w4):
    def _A_ref(x, w_r, w_i):
        B, S, D = x.shape
        X = (lambda x, axes=(-2,-1): torch.fft.rfft2(x.float(), dim=axes))(x, axes=(-2, -1))
        W = w_r + 1j * w_i
        X = X * W
        y = (lambda x, s, axes=(-2,-1): torch.fft.irfft2(x, s=s, dim=axes).to(torch.bfloat16))(X, (S, D), axes=(-2, -1))
        return y

    def _B_ref(x, w1, w2, w3, w4):
        B, S, D = x.shape
        h = _gelu(_layernorm(x, axis=-1) @ w1)
        c = D // 4
        g0 = _pad(h[:, :, 0*c:1*c], ((0, 0), (1, 0), (0, 0)))[:, :S, :]
        g1 = _pad(h[:, :, 1*c:2*c], ((0, 0), (0, 1), (0, 0)))[:, 1:, :]
        g2 = _pad(h[:, :, 2*c:3*c], ((0, 0), (2, 0), (0, 0)))[:, :S, :]
        g3 = _pad(h[:, :, 3*c:   ], ((0, 0), (0, 2), (0, 0)))[:, 2:, :]
        hs = torch.concatenate([g0, g1, g2, g3], axis=-1) @ w2
        x1 = x + hs
        h2 = _gelu(_layernorm(x1, axis=-1) @ w3) @ w4
        return x1 + h2

    x = A_x
    xn = _layernorm(x, axis=-1)
    s = _A_ref(xn, A_w_r, A_w_i)
    g = _silu(_B_ref(xn, B_w1, B_w2, B_w3, B_w4))
    return x + s * g
```

```asm
; @launch grid=(256,1,1) block=(256,1,1) lds=163840
.amdgcn_target "amdgcn-amd-amdhsa--gfx950"
.text
.globl recurrent_scan__spectral_gfnet__mixer_s_mlp__prompt_kernel
.p2align 8
.type recurrent_scan__spectral_gfnet__mixer_s_mlp__prompt_kernel,@function
recurrent_scan__spectral_gfnet__mixer_s_mlp__prompt_kernel:
    s_cmp_ge_u32 s2, 256
    s_cbranch_scc1 Lend
    s_load_dwordx16 s[64:79], s[0:1], 0
    s_load_dwordx4 s[80:83], s[0:1], 64
    s_load_dwordx2 s[84:85], s[0:1], 80
    s_getpc_b64 s[88:89]
Lpc:
    s_mov_b32 s90, Lcode_end-Lpc
    s_mov_b32 s91, 0x20000
    s_lshr_b32 s53, s2, 3
    s_lshl_b32 s52, s53, 11
    v_lshlrev_b32 v12, 3, v0
    v_lshrrev_b32 v1, 6, v0
    buffer_load_dword v4, v12, s[88:91], s52 offen
    v_readfirstlane_b32 s50, v1
    s_and_b32 s52, s2, 7
    s_and_b32 s49, s53, 7
    s_lshr_b32 s53, s53, 3
    s_lshl_b32 s48, s52, 2
    s_add_u32 s48, s48, s53
    v_and_b32 v1, 63, v0
    v_lshlrev_b32 v2, 4, v1
    s_add_u32 s93, s48, s49
    s_and_b32 s93, s93, 3
    v_lshrrev_b32 v3, 4, v1
    v_and_b32 v10, 15, v1
    s_lshl_b32 s52, s50, 2
    v_add_u32 v12, s52, v3
    v_xor_b32 v12, v12, v10
    v_lshlrev_b32 v12, 4, v12
    v_lshl_add_u32 v49, v3, 10, v12
    s_lshl_b32 s4, s48, 6
    s_add_u32 s4, s4, s52
    s_lshl_b32 s4, s4, 10
    s_sub_u32 s4, s4, 2048
    v_add_u32 v50, s4, v49
    v_min_u32 v50, 1073741824, v50
    v_lshrrev_b32 v12, 3, v1
    v_and_b32 v13, 7, v1
    s_and_b32 s52, s52, 4
    v_and_b32 v14, 2, v12
    v_or_b32 v14, s52, v14
    v_xor_b32 v15, v13, v14
    v_lshlrev_b32 v15, 4, v15
    v_lshl_add_u32 v48, v12, 10, v15
    s_lshl_b32 s5, s50, 10
    s_lshl_b32 s6, s50, 13
    s_lshl_b32 s53, s49, 7
    s_add_u32 s6, s6, s53
    s_cmp_eq_u32 s50, 0
    s_cselect_b32 s94, 0, 1073741824
    s_mov_b32 s62, 70656
    s_waitcnt lgkmcnt(0)
    s_mov_b64 s[8:9], s[64:65]
    s_mov_b32 s10, 2097152
    s_mov_b32 s11, 0x20000
    s_mov_b64 s[20:21], s[72:73]
    s_mov_b32 s22, 524288
    s_mov_b32 s23, 0x20000
    s_add_u32 s54, s93, 0
    s_and_b32 s54, s54, 3
    s_lshl_b32 s55, s54, 17
    s_add_u32 s55, s55, s6
    s_lshl_b32 s54, s54, 8
    s_add_u32 m0, s5, 0
    s_add_u32 s7, s54, s4
    buffer_load_dwordx4 v50, s[8:11], s54 offen lds
    s_add_u32 m0, s5, 4096
    s_add_u32 s3, s7, 16384
    buffer_load_dwordx4 v49, s[8:11], s3 offen lds
    s_add_u32 m0, s5, 8192
    s_add_u32 s3, s7, 32768
    buffer_load_dwordx4 v49, s[8:11], s3 offen lds
    s_add_u32 m0, s5, 12288
    s_add_u32 s3, s7, 49152
    buffer_load_dwordx4 v49, s[8:11], s3 offen lds
    s_cmp_eq_u32 s50, 0
    s_cselect_b32 m0, 16384, s62
    s_add_u32 s3, s7, 65536
    s_or_b32 s3, s3, s94
    buffer_load_dwordx4 v49, s[8:11], s3 offen lds
    s_add_u32 m0, s5, 71680
    s_add_u32 s3, s55, 0
    buffer_load_dwordx4 v48, s[20:23], s3 offen lds
    s_add_u32 m0, s5, 75776
    s_add_u32 s3, s55, 32768
    buffer_load_dwordx4 v48, s[20:23], s3 offen lds
    s_add_u32 m0, s5, 79872
    s_add_u32 s3, s55, 65536
    buffer_load_dwordx4 v48, s[20:23], s3 offen lds
    s_add_u32 m0, s5, 83968
    s_add_u32 s3, s55, 98304
    buffer_load_dwordx4 v48, s[20:23], s3 offen lds
    s_mov_b64 s[24:25], s[74:75]
    s_mov_b32 s26, 524288
    s_mov_b32 s27, 0x20000
    s_mov_b64 s[28:29], s[76:77]
    s_mov_b32 s30, 1835008
    s_mov_b32 s31, 0x20000
    s_mov_b64 s[44:45], s[82:83]
    s_mov_b32 s46, 256
    s_mov_b32 s47, 0x20000
    s_mov_b64 s[40:41], s[84:85]
    s_mov_b32 s42, 23068672
    s_mov_b32 s43, 0x20000
    s_mov_b64 s[12:13], s[66:67]
    s_mov_b32 s14, 1052672
    s_mov_b32 s15, 0x20000
    s_mov_b64 s[16:17], s[68:69]
    s_mov_b32 s18, 1052672
    s_mov_b32 s19, 0x20000
    s_mov_b64 s[32:33], s[78:79]
    s_mov_b32 s34, 1835008
    s_mov_b32 s35, 0x20000
    s_mov_b64 s[36:37], s[80:81]
    s_mov_b32 s38, 2097152
    s_mov_b32 s39, 0x20000
    s_or_b32 s58, s2, s50
    s_cbranch_scc1 Lnonce_1
    s_memrealtime s[58:59]
    s_waitcnt lgkmcnt(0)
    s_or_b32 s58, s58, 1
    s_mov_b64 exec, 1
    v_mov_b32 v8, s58
    buffer_store_dword v8, v2, s[44:47], 0 offen sc1
    s_mov_b64 exec, -1
Lnonce_1:
    s_lshl_b32 s92, s48, 3
    s_add_u32 s92, s92, s49
    s_lshl_b32 s92, s92, 7
    s_lshl_b32 s53, s50, 11
    v_and_b32 v16, 31, v1
    v_lshrrev_b32 v17, 5, v1
    v_mul_u32_u24 v17, 3584, v17
    v_lshl_add_u32 v17, v16, 4, v17
    v_cmp_gt_u32 vcc, 28, v16
    v_mov_b32 v16, 1073741824
    s_nop 0
    v_cndmask_b32 v51, v16, v17, vcc
    v_and_b32 v14, 6, v12
    v_xor_b32 v15, v13, v14
    v_lshlrev_b32 v15, 4, v15
    v_lshl_add_u32 v44, v12, 10, v15
    v_add_u32 v45, 7168, v44
    v_add_u32 v46, 14336, v44
    v_add_u32 v47, 21504, v44
    v_mov_b32 v11, 0
    v_lshrrev_b32 v12, 2, v10
    v_and_b32 v13, 3, v1
    v_lshlrev_b32 v13, 3, v13
    v_lshl_add_u32 v57, v12, 7, v13
    v_lshrrev_b32 v14, 1, v12
    v_and_b32 v15, 1, v3
    v_lshl_add_u32 v56, v15, 1, v14
    v_lshrrev_b32 v16, 1, v3
    v_lshlrev_b32 v17, 5, v15
    v_lshl_add_u32 v58, v16, 4, v17
    v_xor_b32 v14, 0, v56
    v_lshl_add_u32 v52, v14, 5, v57
    v_xor_b32 v14, 1, v56
    v_lshl_add_u32 v53, v14, 5, v57
    v_xor_b32 v14, 2, v56
    v_lshl_add_u32 v54, v14, 5, v57
    v_xor_b32 v14, 3, v56
    v_lshl_add_u32 v55, v14, 5, v57
    v_lshl_add_u32 v14, v16, 2, v12
    v_lshl_add_u32 v14, v14, 9, v17
    s_lshl_b32 s52, s50, 6
    s_add_u32 s52, s52, 137216
    v_add3_u32 v59, v14, v13, s52
    v_lshlrev_b32 v14, 11, v16
    v_lshl_add_u32 v14, v15, 9, v14
    s_lshr_b32 s52, s50, 1
    s_lshl_b32 s52, s52, 12
    s_add_u32 s52, s52, 155648
    v_add3_u32 v14, v14, v57, s52
    s_and_b32 s52, s50, 1
    s_lshl_b32 s52, s52, 1
    v_xor_b32 v18, s52, v56
    v_lshl_add_u32 v60, v18, 5, v14
    v_xor_b32 v18, 1, v18
    v_lshl_add_u32 v61, v18, 5, v14
    s_add_u32 s52, s53, 145408
    v_lshl_add_u32 v14, v12, 6, v13
    v_lshl_add_u32 v14, v3, 8, v14
    v_add_u32 v62, s52, v14
    v_lshlrev_b32 v14, 13, v10
    v_lshl_add_u32 v63, v3, 4, v14
    v_lshrrev_b32 v14, 2, v1
    v_mul_u32_u24 v14, 32896, v14
    v_lshl_add_u32 v64, v13, 1, v14
    v_and_b32 v14, 1, v1
    v_lshlrev_b32 v18, 10, v14
    v_lshl_add_u32 v18, v3, 4, v18
    v_add_u32 v66, 153600, v18
    v_lshrrev_b32 v18, 4, v0
    v_lshlrev_b32 v18, 6, v18
    v_lshl_add_u32 v18, v14, 2, v18
    v_bfe_u32 v14, v0, 1, 2
    v_lshl_add_u32 v18, v14, 4, v18
    v_and_b32 v14, 8, v0
    v_add_u32 v18, v18, v14
    v_add_u32 v67, 153600, v18
    s_lshr_b32 s53, s49, 1
    s_sub_u32 s53, s53, s93
    s_and_b32 s53, s53, 3
    s_mul_i32 s53, s53, 17408
    s_lshl_b32 s52, s50, 12
    s_add_u32 s53, s53, s52
    s_and_b32 s52, s49, 1
    s_lshl_b32 s52, s52, 3
    v_add_u32 v14, 2, v10
    v_and_b32 v17, 15, v14
    v_or_b32 v18, s52, v16
    v_xor_b32 v17, v17, v18
    v_lshlrev_b32 v14, 8, v14
    v_lshl_add_u32 v14, v15, 3, v14
    v_add_u32 v14, s53, v14
    v_xor_b32 v18, 0, v17
    v_lshl_add_u32 v68, v18, 4, v14
    v_xor_b32 v18, 2, v17
    v_lshl_add_u32 v69, v18, 4, v14
    v_xor_b32 v18, 4, v17
    v_lshl_add_u32 v70, v18, 4, v14
    v_xor_b32 v18, 6, v17
    v_lshl_add_u32 v71, v18, 4, v14
    s_lshr_b32 s52, s49, 1
    s_lshl_b32 s52, s52, 2
    s_lshr_b32 s52, 0x4031, s52
    s_and_b32 s52, s52, 15
    s_lshl_b32 s53, s50, 4
    s_add_u32 s52, s52, s53
    v_add_u32 v12, s52, v10
    v_and_b32 v13, 15, v12
    v_xor_b32 v13, v13, v3
    v_lshlrev_b32 v12, 8, v12
    v_xor_b32 v14, 0, v13
    v_lshl_add_u32 v72, v14, 4, v12
    v_xor_b32 v14, 4, v13
    v_lshl_add_u32 v73, v14, 4, v12
    v_xor_b32 v14, 8, v13
    v_lshl_add_u32 v74, v14, 4, v12
    v_xor_b32 v14, 12, v13
    v_lshl_add_u32 v75, v14, 4, v12
    v_add_u32 v12, 2, v10
    v_and_b32 v13, 15, v12
    v_xor_b32 v13, v13, v3
    v_lshlrev_b32 v12, 8, v12
    v_xor_b32 v14, 0, v13
    v_lshl_add_u32 v76, v14, 4, v12
    v_xor_b32 v14, 4, v13
    v_lshl_add_u32 v77, v14, 4, v12
    v_xor_b32 v14, 8, v13
    v_lshl_add_u32 v78, v14, 4, v12
    v_xor_b32 v14, 12, v13
    v_lshl_add_u32 v79, v14, 4, v12
    v_lshlrev_b32 v12, 10, v3
    v_add_u32 v12, 71680, v12
    v_mov_b32 v13, 0x3f803f80
    v_add_u32 v80, v12, v52
    v_accvgpr_write_b32 a0, v13
    v_add_u32 v81, v12, v53
    v_accvgpr_write_b32 a1, v13
    v_add_u32 v82, v12, v54
    v_accvgpr_write_b32 a2, v13
    v_add_u32 v83, v12, v55
    v_accvgpr_write_b32 a3, v13
    s_lshl_b32 s64, s48, 16
    s_lshl_b32 s53, s50, 14
    s_add_u32 s64, s64, s53
    s_lshl_b32 s65, s50, 14
    s_lshl_b32 s66, s50, 11
    s_lshl_b32 s67, s92, 4
    s_or_b32 s67, s67, s94
    s_lshr_b32 s68, s48, 1
    s_lshl_b32 s68, s68, 2
    s_and_b32 s53, s48, 1
    s_add_u32 s68, s68, s53
    s_and_b32 s53, s50, 2
    s_add_u32 s68, s68, s53
    s_lshl_b32 s68, s68, 1
    s_and_b32 s53, s50, 1
    s_add_u32 s68, s68, s53
    s_mul_i32 s68, s68, 14336
    s_mul_i32 s53, s49, 448
    s_add_u32 s68, s68, s53
    buffer_load_dwordx4 a[4:7], v2, s[24:27], s67 offen
    buffer_load_dwordx4 a[16:19], v2, s[24:27], s67 offen offset:1024
    s_add_u32 m0, s66, 137216
    s_add_u32 s3, s68, 6144
    buffer_load_dwordx4 v51, s[28:31], s68 offen lds
    buffer_load_dwordx4 v51, s[28:31], s3 offen offset:1024 lds
    s_mul_i32 s69, s49, 229376
    s_lshl_b32 s53, s50, 15
    s_add_u32 s69, s69, s53
    s_add_u32 s69, s69, 18874368
    s_add_u32 s53, s69, 131072
    s_cmp_eq_u32 s50, 3
    s_cselect_b32 s70, 1073741824, s53
    s_lshr_b32 s71, s92, 1
    s_add_u32 s71, s71, 18022400
    s_or_b32 s71, s71, s94
    s_lshr_b32 s72, s50, 1
    s_and_b32 s53, s50, 1
    s_lshl_b32 s53, s53, 10
    s_add_u32 s72, s72, s53
    s_lshl_b32 s53, s48, 1
    s_add_u32 s72, s72, s53
    s_mul_i32 s72, s72, 514
    s_lshl_b32 s53, s49, 6
    s_add_u32 s72, s72, s53
    s_add_u32 s72, s72, 2
    s_lshl_b32 s73, s48, 16
    s_lshl_b32 s53, s50, 14
    s_add_u32 s73, s73, s53
    s_lshl_b32 s53, s49, 7
    s_add_u32 s73, s73, s53
    s_lshl_b32 s74, s48, 10
    s_lshl_b32 s53, s50, 8
    s_add_u32 s74, s74, s53
    s_add_u32 s74, s74, 18087936
    s_lshl_b32 s75, s50, 13
    s_lshl_b32 s53, s49, 7
    s_add_u32 s75, s75, s53
    s_add_u32 s75, s75, 18087936
    s_lshl_b32 s76, s49, 11
    s_lshl_b32 s53, s64, 0
    s_add_u32 s76, s76, s53
    s_lshl_b32 s77, s50, 17
    s_lshl_b32 s53, s49, 7
    s_add_u32 s77, s77, s53
    s_and_b32 s78, s50, 1
    s_lshl_b32 s78, s78, 12
    s_lshr_b32 s53, s50, 1
    s_lshl_b32 s53, s53, 6
    s_add_u32 s78, s78, s53
    s_lshl_b32 s53, s48, 7
    s_add_u32 s78, s78, s53
    s_lshl_b32 s53, s49, 18
    s_add_u32 s78, s78, s53
    s_add_u32 s78, s78, 6291456
    s_mul_i32 s79, s49, 229376
    s_lshl_b32 s53, s48, 13
    s_add_u32 s79, s79, s53
    s_lshl_b32 s53, s50, 11
    s_add_u32 s79, s79, s53
    s_add_u32 s79, s79, 20971520
    s_cmp_lt_u32 s48, 28
    s_cselect_b32 s79, s79, 1073741824
    s_lshl_b32 s80, s49, 18
    s_lshl_b32 s53, s48, 13
    s_add_u32 s80, s80, s53
    s_lshl_b32 s53, s50, 11
    s_add_u32 s80, s80, s53
    s_add_u32 s80, s80, 4194304
    s_lshl_b32 s81, s92, 1
    s_lshl_b32 s53, s50, 6
    s_add_u32 s81, s81, s53
    s_add_u32 s81, s81, 17825792
    s_mov_b32 s53, 0x3ab504f3
    s_cmp_eq_u32 s92, 32640
    s_cselect_b32 s82, 0x3a800000, s53
    s_lshl_b32 s83, s49, 18
    s_lshl_b32 s53, s48, 13
    s_add_u32 s83, s83, s53
    s_lshl_b32 s53, s50, 10
    s_add_u32 s83, s83, s53
    s_add_u32 s83, s83, 6291456
    s_lshr_b32 s84, s48, 3
    s_lshl_b32 s84, s84, 11
    s_and_b32 s53, s48, 7
    s_lshl_b32 s53, s53, 7
    s_add_u32 s84, s84, s53
    s_lshl_b32 s53, s50, 16
    s_add_u32 s84, s84, s53
    s_lshl_b32 s53, s49, 18
    s_add_u32 s84, s84, s53
    s_lshl_b32 s52, s49, 6
    s_lshl_b32 s53, s50, 4
    s_add_u32 s52, s52, s53
    s_lshl_b32 s53, s93, 7
    v_add_u32 v12, s52, v10
    v_and_b32 v13, 1, v12
    v_lshrrev_b32 v12, 1, v12
    v_add_u32 v12, 1, v12
    v_cvt_f32_u32 v12, v12
    v_mul_f32 v12, 0x3b000000, v12
    v_cvt_f32_u32 v13, v13
    v_mul_f32 v13, 0x3e800000, v13
    v_lshl_add_u32 v14, v3, 3, s53
    v_cvt_f32_u32 v14, v14
    v_fma_f32 v13, v14, v12, v13
    v_mul_f32 v14, 0x42000000, v12
    v_add_f32 v16, v13, v14
    v_cos_f32 v14, v14
    v_cos_f32 v148, v13
    v_cos_f32 v156, v16
    v_add_f32 v13, v13, v12
    v_add_f32 v16, v16, v12
    v_cos_f32 v149, v13
    v_cos_f32 v157, v16
    v_add_f32 v13, v13, v12
    v_add_f32 v16, v16, v12
    v_cos_f32 v150, v13
    v_cos_f32 v158, v16
    v_add_f32 v13, v13, v12
    s_add_u32 s54, s93, 1
    s_and_b32 s54, s54, 3
    s_lshl_b32 s55, s54, 17
    s_add_u32 s55, s55, s6
    s_lshl_b32 s54, s54, 8
    s_add_u32 m0, s5, 17408
    s_add_u32 s7, s54, s4
    buffer_load_dwordx4 v50, s[8:11], s54 offen lds
    v_add_f32 v16, v16, v12
    v_cos_f32 v151, v13
    v_cos_f32 v159, v16
    v_add_f32 v13, v13, v12
    v_add_f32 v16, v16, v12
    v_cos_f32 v152, v13
    s_add_u32 m0, s5, 21504
    s_add_u32 s3, s7, 16384
    buffer_load_dwordx4 v49, s[8:11], s3 offen lds
    v_cos_f32 v160, v16
    v_add_f32 v13, v13, v12
    v_add_f32 v16, v16, v12
    v_cos_f32 v153, v13
    v_cos_f32 v161, v16
    v_add_f32 v13, v13, v12
    v_add_f32 v16, v16, v12
    s_add_u32 m0, s5, 25600
    s_add_u32 s3, s7, 32768
    buffer_load_dwordx4 v49, s[8:11], s3 offen lds
    v_cos_f32 v154, v13
    v_cos_f32 v162, v16
    v_add_f32 v13, v13, v12
    v_add_f32 v16, v16, v12
    v_cos_f32 v155, v13
    v_cos_f32 v163, v16
    s_add_u32 m0, s5, 29696
    s_add_u32 s3, s7, 49152
    buffer_load_dwordx4 v49, s[8:11], s3 offen lds
    v_add_f32 v14, v14, v14
    v_cvt_pk_bf16_f32 v84, v148, v149
    v_cvt_pk_bf16_f32 v85, v150, v151
    v_cvt_pk_bf16_f32 v86, v152, v153
    v_cvt_pk_bf16_f32 v87, v154, v155
    v_cvt_pk_bf16_f32 v88, v156, v157
    v_pk_fma_f32 v[148:149], v[156:157], v[14:15], v[148:149] op_sel_hi:[1,0,1] neg_lo:[0,0,1] neg_hi:[0,0,1]
    v_cvt_pk_bf16_f32 v89, v158, v159
    v_pk_fma_f32 v[150:151], v[158:159], v[14:15], v[150:151] op_sel_hi:[1,0,1] neg_lo:[0,0,1] neg_hi:[0,0,1]
    v_cvt_pk_bf16_f32 v90, v160, v161
    s_cmp_eq_u32 s50, 0
    s_cselect_b32 m0, 33792, s62
    s_add_u32 s3, s7, 65536
    s_or_b32 s3, s3, s94
    buffer_load_dwordx4 v49, s[8:11], s3 offen lds
    v_pk_fma_f32 v[152:153], v[160:161], v[14:15], v[152:153] op_sel_hi:[1,0,1] neg_lo:[0,0,1] neg_hi:[0,0,1]
    v_cvt_pk_bf16_f32 v91, v162, v163
    v_pk_fma_f32 v[154:155], v[162:163], v[14:15], v[154:155] op_sel_hi:[1,0,1] neg_lo:[0,0,1] neg_hi:[0,0,1]
    v_cvt_pk_bf16_f32 v92, v148, v149
    v_pk_fma_f32 v[156:157], v[148:149], v[14:15], v[156:157] op_sel_hi:[1,0,1] neg_lo:[0,0,1] neg_hi:[0,0,1]
    v_cvt_pk_bf16_f32 v93, v150, v151
    v_pk_fma_f32 v[158:159], v[150:151], v[14:15], v[158:159] op_sel_hi:[1,0,1] neg_lo:[0,0,1] neg_hi:[0,0,1]
    v_cvt_pk_bf16_f32 v94, v152, v153
    v_pk_fma_f32 v[160:161], v[152:153], v[14:15], v[160:161] op_sel_hi:[1,0,1] neg_lo:[0,0,1] neg_hi:[0,0,1]
    v_cvt_pk_bf16_f32 v95, v154, v155
    s_add_u32 m0, s5, 88064
    s_add_u32 s3, s55, 0
    buffer_load_dwordx4 v48, s[20:23], s3 offen lds
    v_pk_fma_f32 v[162:163], v[154:155], v[14:15], v[162:163] op_sel_hi:[1,0,1] neg_lo:[0,0,1] neg_hi:[0,0,1]
    v_cvt_pk_bf16_f32 v96, v156, v157
    v_pk_fma_f32 v[148:149], v[156:157], v[14:15], v[148:149] op_sel_hi:[1,0,1] neg_lo:[0,0,1] neg_hi:[0,0,1]
    v_cvt_pk_bf16_f32 v97, v158, v159
    v_pk_fma_f32 v[150:151], v[158:159], v[14:15], v[150:151] op_sel_hi:[1,0,1] neg_lo:[0,0,1] neg_hi:[0,0,1]
    v_cvt_pk_bf16_f32 v98, v160, v161
    v_pk_fma_f32 v[152:153], v[160:161], v[14:15], v[152:153] op_sel_hi:[1,0,1] neg_lo:[0,0,1] neg_hi:[0,0,1]
    v_cvt_pk_bf16_f32 v99, v162, v163
    v_pk_fma_f32 v[154:155], v[162:163], v[14:15], v[154:155] op_sel_hi:[1,0,1] neg_lo:[0,0,1] neg_hi:[0,0,1]
    v_cvt_pk_bf16_f32 v100, v148, v149
    s_add_u32 m0, s5, 92160
    s_add_u32 s3, s55, 32768
    buffer_load_dwordx4 v48, s[20:23], s3 offen lds
    v_pk_fma_f32 v[156:157], v[148:149], v[14:15], v[156:157] op_sel_hi:[1,0,1] neg_lo:[0,0,1] neg_hi:[0,0,1]
    v_cvt_pk_bf16_f32 v101, v150, v151
    v_pk_fma_f32 v[158:159], v[150:151], v[14:15], v[158:159] op_sel_hi:[1,0,1] neg_lo:[0,0,1] neg_hi:[0,0,1]
    v_cvt_pk_bf16_f32 v102, v152, v153
    v_pk_fma_f32 v[160:161], v[152:153], v[14:15], v[160:161] op_sel_hi:[1,0,1] neg_lo:[0,0,1] neg_hi:[0,0,1]
    v_cvt_pk_bf16_f32 v103, v154, v155
    v_pk_fma_f32 v[162:163], v[154:155], v[14:15], v[162:163] op_sel_hi:[1,0,1] neg_lo:[0,0,1] neg_hi:[0,0,1]
    v_cvt_pk_bf16_f32 v104, v156, v157
    v_pk_fma_f32 v[148:149], v[156:157], v[14:15], v[148:149] op_sel_hi:[1,0,1] neg_lo:[0,0,1] neg_hi:[0,0,1]
    v_cvt_pk_bf16_f32 v105, v158, v159
    s_add_u32 m0, s5, 96256
    s_add_u32 s3, s55, 65536
    buffer_load_dwordx4 v48, s[20:23], s3 offen lds
    v_pk_fma_f32 v[150:151], v[158:159], v[14:15], v[150:151] op_sel_hi:[1,0,1] neg_lo:[0,0,1] neg_hi:[0,0,1]
    v_cvt_pk_bf16_f32 v106, v160, v161
    v_pk_fma_f32 v[152:153], v[160:161], v[14:15], v[152:153] op_sel_hi:[1,0,1] neg_lo:[0,0,1] neg_hi:[0,0,1]
    v_cvt_pk_bf16_f32 v107, v162, v163
    v_pk_fma_f32 v[154:155], v[162:163], v[14:15], v[154:155] op_sel_hi:[1,0,1] neg_lo:[0,0,1] neg_hi:[0,0,1]
    v_cvt_pk_bf16_f32 v108, v148, v149
    v_pk_fma_f32 v[156:157], v[148:149], v[14:15], v[156:157] op_sel_hi:[1,0,1] neg_lo:[0,0,1] neg_hi:[0,0,1]
    v_cvt_pk_bf16_f32 v109, v150, v151
    v_pk_fma_f32 v[158:159], v[150:151], v[14:15], v[158:159] op_sel_hi:[1,0,1] neg_lo:[0,0,1] neg_hi:[0,0,1]
    v_cvt_pk_bf16_f32 v110, v152, v153
    s_add_u32 m0, s5, 100352
    s_add_u32 s3, s55, 98304
    buffer_load_dwordx4 v48, s[20:23], s3 offen lds
    v_pk_fma_f32 v[160:161], v[152:153], v[14:15], v[160:161] op_sel_hi:[1,0,1] neg_lo:[0,0,1] neg_hi:[0,0,1]
    v_cvt_pk_bf16_f32 v111, v154, v155
    v_pk_fma_f32 v[162:163], v[154:155], v[14:15], v[162:163] op_sel_hi:[1,0,1] neg_lo:[0,0,1] neg_hi:[0,0,1]
    v_cvt_pk_bf16_f32 v112, v156, v157
    v_pk_fma_f32 v[148:149], v[156:157], v[14:15], v[148:149] op_sel_hi:[1,0,1] neg_lo:[0,0,1] neg_hi:[0,0,1]
    v_cvt_pk_bf16_f32 v113, v158, v159
    v_pk_fma_f32 v[150:151], v[158:159], v[14:15], v[150:151] op_sel_hi:[1,0,1] neg_lo:[0,0,1] neg_hi:[0,0,1]
    v_cvt_pk_bf16_f32 v114, v160, v161
    v_pk_fma_f32 v[152:153], v[160:161], v[14:15], v[152:153] op_sel_hi:[1,0,1] neg_lo:[0,0,1] neg_hi:[0,0,1]
    v_cvt_pk_bf16_f32 v115, v162, v163
    buffer_load_dword v7, v11, s[44:47], 0 offen sc1
    v_pk_fma_f32 v[154:155], v[162:163], v[14:15], v[154:155] op_sel_hi:[1,0,1] neg_lo:[0,0,1] neg_hi:[0,0,1]
    v_cvt_pk_bf16_f32 v116, v148, v149
    v_pk_fma_f32 v[156:157], v[148:149], v[14:15], v[156:157] op_sel_hi:[1,0,1] neg_lo:[0,0,1] neg_hi:[0,0,1]
    v_cvt_pk_bf16_f32 v117, v150, v151
    v_pk_fma_f32 v[158:159], v[150:151], v[14:15], v[158:159] op_sel_hi:[1,0,1] neg_lo:[0,0,1] neg_hi:[0,0,1]
    v_cvt_pk_bf16_f32 v118, v152, v153
    v_pk_fma_f32 v[160:161], v[152:153], v[14:15], v[160:161] op_sel_hi:[1,0,1] neg_lo:[0,0,1] neg_hi:[0,0,1]
    v_cvt_pk_bf16_f32 v119, v154, v155
    v_pk_fma_f32 v[162:163], v[154:155], v[14:15], v[162:163] op_sel_hi:[1,0,1] neg_lo:[0,0,1] neg_hi:[0,0,1]
    v_cvt_pk_bf16_f32 v120, v156, v157
    v_pk_fma_f32 v[148:149], v[156:157], v[14:15], v[148:149] op_sel_hi:[1,0,1] neg_lo:[0,0,1] neg_hi:[0,0,1]
    v_cvt_pk_bf16_f32 v121, v158, v159
    v_pk_fma_f32 v[150:151], v[158:159], v[14:15], v[150:151] op_sel_hi:[1,0,1] neg_lo:[0,0,1] neg_hi:[0,0,1]
    v_cvt_pk_bf16_f32 v122, v160, v161
    v_pk_fma_f32 v[152:153], v[160:161], v[14:15], v[152:153] op_sel_hi:[1,0,1] neg_lo:[0,0,1] neg_hi:[0,0,1]
    v_cvt_pk_bf16_f32 v123, v162, v163
    v_pk_fma_f32 v[154:155], v[162:163], v[14:15], v[154:155] op_sel_hi:[1,0,1] neg_lo:[0,0,1] neg_hi:[0,0,1]
    v_cvt_pk_bf16_f32 v124, v148, v149
    v_pk_fma_f32 v[156:157], v[148:149], v[14:15], v[156:157] op_sel_hi:[1,0,1] neg_lo:[0,0,1] neg_hi:[0,0,1]
    v_cvt_pk_bf16_f32 v125, v150, v151
    v_pk_fma_f32 v[158:159], v[150:151], v[14:15], v[158:159] op_sel_hi:[1,0,1] neg_lo:[0,0,1] neg_hi:[0,0,1]
    v_cvt_pk_bf16_f32 v126, v152, v153
    v_pk_fma_f32 v[160:161], v[152:153], v[14:15], v[160:161] op_sel_hi:[1,0,1] neg_lo:[0,0,1] neg_hi:[0,0,1]
    v_cvt_pk_bf16_f32 v127, v154, v155
    v_pk_fma_f32 v[162:163], v[154:155], v[14:15], v[162:163] op_sel_hi:[1,0,1] neg_lo:[0,0,1] neg_hi:[0,0,1]
    v_cvt_pk_bf16_f32 v128, v156, v157
    v_pk_fma_f32 v[148:149], v[156:157], v[14:15], v[148:149] op_sel_hi:[1,0,1] neg_lo:[0,0,1] neg_hi:[0,0,1]
    v_cvt_pk_bf16_f32 v129, v158, v159
    v_pk_fma_f32 v[150:151], v[158:159], v[14:15], v[150:151] op_sel_hi:[1,0,1] neg_lo:[0,0,1] neg_hi:[0,0,1]
    v_cvt_pk_bf16_f32 v130, v160, v161
    v_pk_fma_f32 v[152:153], v[160:161], v[14:15], v[152:153] op_sel_hi:[1,0,1] neg_lo:[0,0,1] neg_hi:[0,0,1]
    v_cvt_pk_bf16_f32 v131, v162, v163
    v_pk_fma_f32 v[154:155], v[162:163], v[14:15], v[154:155] op_sel_hi:[1,0,1] neg_lo:[0,0,1] neg_hi:[0,0,1]
    v_cvt_pk_bf16_f32 v132, v148, v149
    v_pk_fma_f32 v[156:157], v[148:149], v[14:15], v[156:157] op_sel_hi:[1,0,1] neg_lo:[0,0,1] neg_hi:[0,0,1]
    v_cvt_pk_bf16_f32 v133, v150, v151
    v_pk_fma_f32 v[158:159], v[150:151], v[14:15], v[158:159] op_sel_hi:[1,0,1] neg_lo:[0,0,1] neg_hi:[0,0,1]
    v_cvt_pk_bf16_f32 v134, v152, v153
    v_pk_fma_f32 v[160:161], v[152:153], v[14:15], v[160:161] op_sel_hi:[1,0,1] neg_lo:[0,0,1] neg_hi:[0,0,1]
    v_cvt_pk_bf16_f32 v135, v154, v155
    v_pk_fma_f32 v[162:163], v[154:155], v[14:15], v[162:163] op_sel_hi:[1,0,1] neg_lo:[0,0,1] neg_hi:[0,0,1]
    v_cvt_pk_bf16_f32 v136, v156, v157
    v_pk_fma_f32 v[148:149], v[156:157], v[14:15], v[148:149] op_sel_hi:[1,0,1] neg_lo:[0,0,1] neg_hi:[0,0,1]
    v_cvt_pk_bf16_f32 v137, v158, v159
    v_pk_fma_f32 v[150:151], v[158:159], v[14:15], v[150:151] op_sel_hi:[1,0,1] neg_lo:[0,0,1] neg_hi:[0,0,1]
    v_cvt_pk_bf16_f32 v138, v160, v161
    v_pk_fma_f32 v[152:153], v[160:161], v[14:15], v[152:153] op_sel_hi:[1,0,1] neg_lo:[0,0,1] neg_hi:[0,0,1]
    v_cvt_pk_bf16_f32 v139, v162, v163
    v_pk_fma_f32 v[154:155], v[162:163], v[14:15], v[154:155] op_sel_hi:[1,0,1] neg_lo:[0,0,1] neg_hi:[0,0,1]
    v_cvt_pk_bf16_f32 v140, v148, v149
    v_pk_fma_f32 v[156:157], v[148:149], v[14:15], v[156:157] op_sel_hi:[1,0,1] neg_lo:[0,0,1] neg_hi:[0,0,1]
    v_cvt_pk_bf16_f32 v141, v150, v151
    v_pk_fma_f32 v[158:159], v[150:151], v[14:15], v[158:159] op_sel_hi:[1,0,1] neg_lo:[0,0,1] neg_hi:[0,0,1]
    v_cvt_pk_bf16_f32 v142, v152, v153
    v_pk_fma_f32 v[160:161], v[152:153], v[14:15], v[160:161] op_sel_hi:[1,0,1] neg_lo:[0,0,1] neg_hi:[0,0,1]
    v_cvt_pk_bf16_f32 v143, v154, v155
    v_pk_fma_f32 v[162:163], v[154:155], v[14:15], v[162:163] op_sel_hi:[1,0,1] neg_lo:[0,0,1] neg_hi:[0,0,1]
    v_cvt_pk_bf16_f32 v144, v156, v157
    v_cvt_pk_bf16_f32 v145, v158, v159
    v_cvt_pk_bf16_f32 v146, v160, v161
    v_cvt_pk_bf16_f32 v147, v162, v163
    s_waitcnt vmcnt(14)
    s_barrier
    ds_read_b128 v[156:159], v72 offset:0
    ds_read_b64_tr_b16 a[32:33], v80 offset:0
    ds_read_b64_tr_b16 a[34:35], v80 offset:512
    ds_read_b64_tr_b16 a[36:37], v81 offset:0
    ds_read_b64_tr_b16 a[38:39], v81 offset:512
    ds_read_b64_tr_b16 a[40:41], v82 offset:0
    ds_read_b64_tr_b16 a[42:43], v82 offset:512
    ds_read_b64_tr_b16 a[44:45], v83 offset:0
    ds_read_b64_tr_b16 a[46:47], v83 offset:512
    ds_read_b128 v[160:163], v73 offset:0
    ds_read_b64_tr_b16 a[48:49], v80 offset:4096
    ds_read_b64_tr_b16 a[50:51], v80 offset:4608
    ds_read_b64_tr_b16 a[52:53], v81 offset:4096
    ds_read_b64_tr_b16 a[54:55], v81 offset:4608
    ds_read_b64_tr_b16 a[56:57], v82 offset:4096
    ds_read_b64_tr_b16 a[58:59], v82 offset:4608
    ds_read_b64_tr_b16 a[60:61], v83 offset:4096
    ds_read_b64_tr_b16 a[62:63], v83 offset:4608
    s_waitcnt lgkmcnt(9)
    v_mfma_f32_16x16x32_bf16 v[188:191], a[32:35], v[156:159], 0
    ds_read_b128 v[164:167], v74 offset:0
    v_mfma_f32_16x16x32_bf16 v[192:195], a[36:39], v[156:159], 0
    ds_read_b64_tr_b16 a[64:65], v80 offset:8192
    v_mfma_f32_16x16x32_bf16 v[196:199], a[40:43], v[156:159], 0
    ds_read_b64_tr_b16 a[66:67], v80 offset:8704
    s_add_u32 s54, s93, 2
    s_and_b32 s54, s54, 3
    s_lshl_b32 s55, s54, 17
    s_add_u32 s55, s55, s6
    s_lshl_b32 s54, s54, 8
    s_add_u32 m0, s5, 34816
    s_add_u32 s7, s54, s4
    buffer_load_dwordx4 v50, s[8:11], s54 offen lds
    v_mfma_f32_16x16x32_bf16 v[200:203], a[44:47], v[156:159], 0
    ds_read_b64_tr_b16 a[68:69], v81 offset:8192
    v_mfma_f32_16x16x32_bf16 v[204:207], a[32:35], a[0:3], 0
    ds_read_b64_tr_b16 a[70:71], v81 offset:8704
    v_mfma_f32_16x16x32_bf16 v[208:211], a[36:39], a[0:3], 0
    ds_read_b64_tr_b16 a[72:73], v82 offset:8192
    v_mfma_f32_16x16x32_bf16 v[212:215], a[40:43], a[0:3], 0
    ds_read_b64_tr_b16 a[74:75], v82 offset:8704
    s_add_u32 m0, s5, 38912
    s_add_u32 s3, s7, 16384
    buffer_load_dwordx4 v49, s[8:11], s3 offen lds
    v_mfma_f32_16x16x32_bf16 v[216:219], a[44:47], a[0:3], 0
    ds_read_b64_tr_b16 a[76:77], v83 offset:8192
    v_mfma_f32_16x16x32_bf16 v[220:223], a[0:3], v[156:159], 0
    ds_read_b64_tr_b16 a[78:79], v83 offset:8704
    v_mfma_f32_16x16x32_bf16 v[224:227], v[156:159], v[156:159], 0
    s_waitcnt lgkmcnt(9)
    v_mfma_f32_16x16x32_bf16 v[188:191], a[48:51], v[160:163], v[188:191]
    ds_read_b128 v[156:159], v75 offset:0
    s_add_u32 m0, s5, 43008
    s_add_u32 s3, s7, 32768
    buffer_load_dwordx4 v49, s[8:11], s3 offen lds
    v_mfma_f32_16x16x32_bf16 v[192:195], a[52:55], v[160:163], v[192:195]
    ds_read_b64_tr_b16 a[32:33], v80 offset:12288
    v_mfma_f32_16x16x32_bf16 v[196:199], a[56:59], v[160:163], v[196:199]
    ds_read_b64_tr_b16 a[34:35], v80 offset:12800
    v_mfma_f32_16x16x32_bf16 v[200:203], a[60:63], v[160:163], v[200:203]
    ds_read_b64_tr_b16 a[36:37], v81 offset:12288
    v_mfma_f32_16x16x32_bf16 v[204:207], a[48:51], a[0:3], v[204:207]
    ds_read_b64_tr_b16 a[38:39], v81 offset:12800
    s_add_u32 m0, s5, 47104
    s_add_u32 s3, s7, 49152
    buffer_load_dwordx4 v49, s[8:11], s3 offen lds
    v_mfma_f32_16x16x32_bf16 v[208:211], a[52:55], a[0:3], v[208:211]
    ds_read_b64_tr_b16 a[40:41], v82 offset:12288
    v_mfma_f32_16x16x32_bf16 v[212:215], a[56:59], a[0:3], v[212:215]
    ds_read_b64_tr_b16 a[42:43], v82 offset:12800
    v_mfma_f32_16x16x32_bf16 v[216:219], a[60:63], a[0:3], v[216:219]
    ds_read_b64_tr_b16 a[44:45], v83 offset:12288
    v_mfma_f32_16x16x32_bf16 v[220:223], a[0:3], v[160:163], v[220:223]
    ds_read_b64_tr_b16 a[46:47], v83 offset:12800
    s_cmp_eq_u32 s50, 0
    s_cselect_b32 m0, 51200, s62
    s_add_u32 s3, s7, 65536
    s_or_b32 s3, s3, s94
    buffer_load_dwordx4 v49, s[8:11], s3 offen lds
    v_mfma_f32_16x16x32_bf16 v[224:227], v[160:163], v[160:163], v[224:227]
    s_waitcnt lgkmcnt(9)
    s_waitcnt vmcnt(6)
    s_barrier
    v_mfma_f32_16x16x32_bf16 v[188:191], a[64:67], v[164:167], v[188:191]
    ds_read_b128 v[160:163], v72 offset:17408
    v_mfma_f32_16x16x32_bf16 v[192:195], a[68:71], v[164:167], v[192:195]
    ds_read_b64_tr_b16 a[48:49], v80 offset:16384
    v_mfma_f32_16x16x32_bf16 v[196:199], a[72:75], v[164:167], v[196:199]
    ds_read_b64_tr_b16 a[50:51], v80 offset:16896
    s_add_u32 m0, s5, 104448
    s_add_u32 s3, s55, 0
    buffer_load_dwordx4 v48, s[20:23], s3 offen lds
    v_mfma_f32_16x16x32_bf16 v[200:203], a[76:79], v[164:167], v[200:203]
    ds_read_b64_tr_b16 a[52:53], v81 offset:16384
    v_mfma_f32_16x16x32_bf16 v[204:207], a[64:67], a[0:3], v[204:207]
    ds_read_b64_tr_b16 a[54:55], v81 offset:16896
    v_mfma_f32_16x16x32_bf16 v[208:211], a[68:71], a[0:3], v[208:211]
    ds_read_b64_tr_b16 a[56:57], v82 offset:16384
    ds_read_b64_tr_b16 a[96:97], v59 offset:0
    v_mfma_f32_16x16x32_bf16 v[212:215], a[72:75], a[0:3], v[212:215]
    ds_read_b64_tr_b16 a[58:59], v82 offset:16896
    s_add_u32 m0, s5, 108544
    s_add_u32 s3, s55, 32768
    buffer_load_dwordx4 v48, s[20:23], s3 offen lds
    v_mfma_f32_16x16x32_bf16 v[216:219], a[76:79], a[0:3], v[216:219]
    ds_read_b64_tr_b16 a[60:61], v83 offset:16384
    ds_read_b64_tr_b16 a[98:99], v59 offset:4096
    v_mfma_f32_16x16x32_bf16 v[220:223], a[0:3], v[164:167], v[220:223]
    ds_read_b64_tr_b16 a[62:63], v83 offset:16896
    ds_read_b64_tr_b16 a[100:101], v59 offset:256
    v_mfma_f32_16x16x32_bf16 v[224:227], v[164:167], v[164:167], v[224:227]
    ds_read_b64_tr_b16 a[102:103], v59 offset:4352
    s_waitcnt lgkmcnt(13)
    v_mfma_f32_16x16x32_bf16 v[188:191], a[32:35], v[156:159], v[188:191]
    ds_read_b128 v[164:167], v73 offset:17408
    s_add_u32 m0, s5, 112640
    s_add_u32 s3, s55, 65536
    buffer_load_dwordx4 v48, s[20:23], s3 offen lds
    v_mfma_f32_16x16x32_bf16 v[192:195], a[36:39], v[156:159], v[192:195]
    ds_read_b64_tr_b16 a[64:65], v80 offset:20480
    v_mfma_f32_16x16x32_bf16 v[196:199], a[40:43], v[156:159], v[196:199]
    ds_read_b64_tr_b16 a[66:67], v80 offset:20992
    v_mfma_f32_16x16x32_bf16 v[200:203], a[44:47], v[156:159], v[200:203]
    ds_read_b64_tr_b16 a[68:69], v81 offset:20480
    v_mfma_f32_16x16x32_bf16 v[204:207], a[32:35], a[0:3], v[204:207]
    ds_read_b64_tr_b16 a[70:71], v81 offset:20992
    s_add_u32 m0, s5, 116736
    s_add_u32 s3, s55, 98304
    buffer_load_dwordx4 v48, s[20:23], s3 offen lds
    v_mfma_f32_16x16x32_bf16 v[208:211], a[36:39], a[0:3], v[208:211]
    ds_read_b64_tr_b16 a[72:73], v82 offset:20480
    s_lshl_b32 s53, s48, 10
    v_mfma_f32_16x16x32_bf16 v[212:215], a[40:43], a[0:3], v[212:215]
    ds_read_b64_tr_b16 a[74:75], v82 offset:20992
    s_add_u32 s52, s53, s69
    v_mfma_f32_16x16x32_bf16 v[216:219], a[44:47], a[0:3], v[216:219]
    ds_read_b64_tr_b16 a[76:77], v83 offset:20480
    s_add_u32 s53, s53, s70
    v_mfma_f32_16x16x32_bf16 v[220:223], a[0:3], v[156:159], v[220:223]
    ds_read_b64_tr_b16 a[78:79], v83 offset:20992
    s_waitcnt lgkmcnt(12)
    buffer_store_dwordx4 a[96:99], v2, s[40:43], s52 offen sc1
    v_mfma_f32_16x16x32_bf16 v[224:227], v[156:159], v[156:159], v[224:227]
    s_waitcnt lgkmcnt(9)
    buffer_store_dwordx4 a[100:103], v2, s[40:43], s53 offen sc1
    s_waitcnt vmcnt(11)
    v_readfirstlane_b32 s51, v7
    s_nop 0
    s_cmp_lg_u32 s51, 0
    s_cbranch_scc1 Lskip_3
    s_mov_b32 s56, 0
    v_mov_b32 v5, 0
Lpoll_4:
    buffer_load_dword v4, v5, s[44:47], 0 offen sc1
    s_waitcnt vmcnt(0)
    v_readfirstlane_b32 s51, v4
    s_add_u32 s56, s56, 1
    s_cmp_lg_u32 s51, 0
    s_cbranch_scc1 Lskip_3
    s_cmp_lt_u32 s56, 0x40000
    s_cbranch_scc1 Lpoll_4
Lskip_3:
    v_mfma_f32_16x16x32_bf16 v[168:171], a[0:3], a[4:7], 0
    v_mfma_f32_16x16x32_bf16 v[172:175], a[0:3], a[16:19], 0
    v_mfma_f32_16x16x32_bf16 v[188:191], a[48:51], v[160:163], v[188:191]
    ds_read_b128 v[156:159], v74 offset:17408
    v_mfma_f32_16x16x32_bf16 v[192:195], a[52:55], v[160:163], v[192:195]
    ds_read_b64_tr_b16 a[32:33], v80 offset:24576
    v_mfma_f32_16x16x32_bf16 v[196:199], a[56:59], v[160:163], v[196:199]
    ds_read_b64_tr_b16 a[34:35], v80 offset:25088
    s_add_u32 s54, s93, 3
    s_and_b32 s54, s54, 3
    s_lshl_b32 s55, s54, 17
    s_add_u32 s55, s55, s6
    s_lshl_b32 s54, s54, 8
    s_add_u32 m0, s5, 52224
    s_add_u32 s7, s54, s4
    buffer_load_dwordx4 v50, s[8:11], s54 offen lds
    v_mfma_f32_16x16x32_bf16 v[200:203], a[60:63], v[160:163], v[200:203]
    ds_read_b64_tr_b16 a[36:37], v81 offset:24576
    v_mfma_f32_16x16x32_bf16 v[204:207], a[48:51], a[0:3], v[204:207]
    ds_read_b64_tr_b16 a[38:39], v81 offset:25088
    v_mfma_f32_16x16x32_bf16 v[208:211], a[52:55], a[0:3], v[208:211]
    ds_read_b64_tr_b16 a[40:41], v82 offset:24576
    v_add_f32_dpp v168, v168, v168 row_ror:8 row_mask:0xf bank_mask:0xf
    v_mfma_f32_16x16x32_bf16 v[212:215], a[56:59], a[0:3], v[212:215]
    ds_read_b64_tr_b16 a[42:43], v82 offset:25088
    s_add_u32 m0, s5, 56320
    s_add_u32 s3, s7, 16384
    buffer_load_dwordx4 v49, s[8:11], s3 offen lds
    v_mfma_f32_16x16x32_bf16 v[216:219], a[60:63], a[0:3], v[216:219]
    ds_read_b64_tr_b16 a[44:45], v83 offset:24576
    v_add_f32_dpp v172, v172, v172 row_ror:8 row_mask:0xf bank_mask:0xf
    v_mfma_f32_16x16x32_bf16 v[220:223], a[0:3], v[160:163], v[220:223]
    ds_read_b64_tr_b16 a[46:47], v83 offset:25088
    v_add_f32_dpp v168, v168, v168 row_ror:4 row_mask:0xf bank_mask:0xf
    v_mfma_f32_16x16x32_bf16 v[224:227], v[160:163], v[160:163], v[224:227]
    v_add_f32_dpp v172, v172, v172 row_ror:4 row_mask:0xf bank_mask:0xf
    s_waitcnt lgkmcnt(9)
    v_mfma_f32_16x16x32_bf16 v[188:191], a[64:67], v[164:167], v[188:191]
    ds_read_b128 v[160:163], v75 offset:17408
    s_add_u32 m0, s5, 60416
    s_add_u32 s3, s7, 32768
    buffer_load_dwordx4 v49, s[8:11], s3 offen lds
    v_mfma_f32_16x16x32_bf16 v[192:195], a[68:71], v[164:167], v[192:195]
    ds_read_b64_tr_b16 a[48:49], v80 offset:28672
    v_mfma_f32_16x16x32_bf16 v[196:199], a[72:75], v[164:167], v[196:199]
    ds_read_b64_tr_b16 a[50:51], v80 offset:29184
    v_mfma_f32_16x16x32_bf16 v[200:203], a[76:79], v[164:167], v[200:203]
    ds_read_b64_tr_b16 a[52:53], v81 offset:28672
    v_mfma_f32_16x16x32_bf16 v[204:207], a[64:67], a[0:3], v[204:207]
    ds_read_b64_tr_b16 a[54:55], v81 offset:29184
    s_add_u32 m0, s5, 64512
    s_add_u32 s3, s7, 49152
    buffer_load_dwordx4 v49, s[8:11], s3 offen lds
    v_mfma_f32_16x16x32_bf16 v[208:211], a[68:71], a[0:3], v[208:211]
    ds_read_b64_tr_b16 a[56:57], v82 offset:28672
    v_add_f32_dpp v168, v168, v168 row_ror:2 row_mask:0xf bank_mask:0xf
    v_mfma_f32_16x16x32_bf16 v[212:215], a[72:75], a[0:3], v[212:215]
    ds_read_b64_tr_b16 a[58:59], v82 offset:29184
    v_add_f32_dpp v172, v172, v172 row_ror:2 row_mask:0xf bank_mask:0xf
    v_mfma_f32_16x16x32_bf16 v[216:219], a[76:79], a[0:3], v[216:219]
    ds_read_b64_tr_b16 a[60:61], v83 offset:28672
    v_add_f32_dpp v168, v168, v168 row_ror:1 row_mask:0xf bank_mask:0xf
    v_mfma_f32_16x16x32_bf16 v[220:223], a[0:3], v[164:167], v[220:223]
    ds_read_b64_tr_b16 a[62:63], v83 offset:29184
    s_cmp_eq_u32 s50, 0
    s_cselect_b32 m0, 68608, s62
    s_add_u32 s3, s7, 65536
    s_or_b32 s3, s3, s94
    buffer_load_dwordx4 v49, s[8:11], s3 offen lds
    v_mfma_f32_16x16x32_bf16 v[224:227], v[164:167], v[164:167], v[224:227]
    v_add_f32_dpp v172, v172, v172 row_ror:1 row_mask:0xf bank_mask:0xf
    s_waitcnt lgkmcnt(9)
    s_waitcnt vmcnt(7)
    s_barrier
    v_mfma_f32_16x16x32_bf16 v[188:191], a[32:35], v[156:159], v[188:191]
    ds_read_b128 v[164:167], v72 offset:34816
    v_mfma_f32_16x16x32_bf16 v[192:195], a[36:39], v[156:159], v[192:195]
    ds_read_b64_tr_b16 a[64:65], v80 offset:32768
    v_mfma_f32_16x16x32_bf16 v[196:199], a[40:43], v[156:159], v[196:199]
    ds_read_b64_tr_b16 a[66:67], v80 offset:33280
    s_add_u32 m0, s5, 120832
    s_add_u32 s3, s55, 0
    buffer_load_dwordx4 v48, s[20:23], s3 offen lds
    v_mfma_f32_16x16x32_bf16 v[200:203], a[44:47], v[156:159], v[200:203]
    ds_read_b64_tr_b16 a[68:69], v81 offset:32768
    v_mfma_f32_16x16x32_bf16 v[204:207], a[32:35], a[0:3], v[204:207]
    ds_read_b64_tr_b16 a[70:71], v81 offset:33280
    v_mfma_f32_16x16x32_bf16 v[208:211], a[36:39], a[0:3], v[208:211]
    ds_read_b64_tr_b16 a[72:73], v82 offset:32768
    v_mul_f32 v168, 0x3b000000, v168
    v_mfma_f32_16x16x32_bf16 v[212:215], a[40:43], a[0:3], v[212:215]
    ds_read_b64_tr_b16 a[74:75], v82 offset:33280
    s_add_u32 m0, s5, 124928
    s_add_u32 s3, s55, 32768
    buffer_load_dwordx4 v48, s[20:23], s3 offen lds
    v_mfma_f32_16x16x32_bf16 v[216:219], a[44:47], a[0:3], v[216:219]
    ds_read_b64_tr_b16 a[76:77], v83 offset:32768
    v_mul_f32 v170, 0x3b000000, v172
    v_mfma_f32_16x16x32_bf16 v[220:223], a[0:3], v[156:159], v[220:223]
    ds_read_b64_tr_b16 a[78:79], v83 offset:33280
    v_cvt_pk_bf16_f32 v169, v168, v170
    v_mfma_f32_16x16x32_bf16 v[224:227], v[156:159], v[156:159], v[224:227]
    v_and_b32 v171, 0xffff0000, v169
    s_waitcnt lgkmcnt(9)
    v_mfma_f32_16x16x32_bf16 v[188:191], a[48:51], v[160:163], v[188:191]
    ds_read_b128 v[156:159], v73 offset:34816
    s_add_u32 m0, s5, 129024
    s_add_u32 s3, s55, 65536
    buffer_load_dwordx4 v48, s[20:23], s3 offen lds
    v_mfma_f32_16x16x32_bf16 v[192:195], a[52:55], v[160:163], v[192:195]
    ds_read_b64_tr_b16 a[32:33], v80 offset:36864
    v_mfma_f32_16x16x32_bf16 v[196:199], a[56:59], v[160:163], v[196:199]
    ds_read_b64_tr_b16 a[34:35], v80 offset:37376
    v_mfma_f32_16x16x32_bf16 v[200:203], a[60:63], v[160:163], v[200:203]
    ds_read_b64_tr_b16 a[36:37], v81 offset:36864
    v_mfma_f32_16x16x32_bf16 v[204:207], a[48:51], a[0:3], v[204:207]
    ds_read_b64_tr_b16 a[38:39], v81 offset:37376
    s_add_u32 m0, s5, 133120
    s_add_u32 s3, s55, 98304
    buffer_load_dwordx4 v48, s[20:23], s3 offen lds
    v_mfma_f32_16x16x32_bf16 v[208:211], a[52:55], a[0:3], v[208:211]
    ds_read_b64_tr_b16 a[40:41], v82 offset:36864
    v_lshlrev_b32 v169, 16, v169
    v_mfma_f32_16x16x32_bf16 v[212:215], a[56:59], a[0:3], v[212:215]
    ds_read_b64_tr_b16 a[42:43], v82 offset:37376
    v_sub_f32 v169, v168, v169
    v_mfma_f32_16x16x32_bf16 v[216:219], a[60:63], a[0:3], v[216:219]
    ds_read_b64_tr_b16 a[44:45], v83 offset:36864
    v_sub_f32 v171, v170, v171
    v_mfma_f32_16x16x32_bf16 v[220:223], a[0:3], v[160:163], v[220:223]
    ds_read_b64_tr_b16 a[46:47], v83 offset:37376
    v_cvt_pk_bf16_f32 v168, v168, v169
    v_mfma_f32_16x16x32_bf16 v[224:227], v[160:163], v[160:163], v[224:227]
    v_cvt_pk_bf16_f32 v170, v170, v171
    s_waitcnt lgkmcnt(9)
    v_mfma_f32_16x16x32_bf16 v[188:191], a[64:67], v[164:167], v[188:191]
    ds_read_b128 v[160:163], v74 offset:34816
    v_mfma_f32_16x16x32_bf16 v[192:195], a[68:71], v[164:167], v[192:195]
    ds_read_b64_tr_b16 a[48:49], v80 offset:40960
    v_mfma_f32_16x16x32_bf16 v[196:199], a[72:75], v[164:167], v[196:199]
    ds_read_b64_tr_b16 a[50:51], v80 offset:41472
    buffer_load_dwordx4 v[148:151], v64, s[12:15], s72 offen
    v_mfma_f32_16x16x32_bf16 v[200:203], a[76:79], v[164:167], v[200:203]
    ds_read_b64_tr_b16 a[52:53], v81 offset:40960
    v_mfma_f32_16x16x32_bf16 v[204:207], a[64:67], a[0:3], v[204:207]
    ds_read_b64_tr_b16 a[54:55], v81 offset:41472
    v_mfma_f32_16x16x32_bf16 v[208:211], a[68:71], a[0:3], v[208:211]
    ds_read_b64_tr_b16 a[56:57], v82 offset:40960
    v_mov_b32 v169, s51
    v_mfma_f32_16x16x32_bf16 v[212:215], a[72:75], a[0:3], v[212:215]
    ds_read_b64_tr_b16 a[58:59], v82 offset:41472
    buffer_load_dwordx4 v[152:155], v64, s[16:19], s72 offen
    v_mfma_f32_16x16x32_bf16 v[216:219], a[76:79], a[0:3], v[216:219]
    ds_read_b64_tr_b16 a[60:61], v83 offset:40960
    v_mov_b32 v171, s51
    v_mfma_f32_16x16x32_bf16 v[220:223], a[0:3], v[164:167], v[220:223]
    ds_read_b64_tr_b16 a[62:63], v83 offset:41472
    s_mov_b64 exec, 15
    buffer_store_dwordx4 v[168:171], v2, s[40:43], s71 offen sc1
    s_mov_b64 exec, -1
    v_mfma_f32_16x16x32_bf16 v[224:227], v[164:167], v[164:167], v[224:227]
    s_waitcnt lgkmcnt(9)
    v_mfma_f32_16x16x32_bf16 v[188:191], a[32:35], v[156:159], v[188:191]
    ds_read_b128 v[164:167], v75 offset:34816
    s_add_u32 m0, s66, 155648
    s_nop 0
    buffer_load_dwordx4 v44, s[32:35], s73 offen lds
    v_mfma_f32_16x16x32_bf16 v[192:195], a[36:39], v[156:159], v[192:195]
    ds_read_b64_tr_b16 a[64:65], v80 offset:45056
    v_mfma_f32_16x16x32_bf16 v[196:199], a[40:43], v[156:159], v[196:199]
    ds_read_b64_tr_b16 a[66:67], v80 offset:45568
    v_mfma_f32_16x16x32_bf16 v[200:203], a[44:47], v[156:159], v[200:203]
    ds_read_b64_tr_b16 a[68:69], v81 offset:45056
    v_mfma_f32_16x16x32_bf16 v[204:207], a[32:35], a[0:3], v[204:207]
    ds_read_b64_tr_b16 a[70:71], v81 offset:45568
    s_add_u32 m0, s66, 155648
    s_nop 0
    buffer_load_dwordx4 v45, s[32:35], s73 offen offset:1024 lds
    v_mfma_f32_16x16x32_bf16 v[208:211], a[36:39], a[0:3], v[208:211]
    ds_read_b64_tr_b16 a[72:73], v82 offset:45056
    v_mfma_f32_16x16x32_bf16 v[212:215], a[40:43], a[0:3], v[212:215]
    ds_read_b64_tr_b16 a[74:75], v82 offset:45568
    v_mfma_f32_16x16x32_bf16 v[216:219], a[44:47], a[0:3], v[216:219]
    ds_read_b64_tr_b16 a[76:77], v83 offset:45056
    v_mfma_f32_16x16x32_bf16 v[220:223], a[0:3], v[156:159], v[220:223]
    ds_read_b64_tr_b16 a[78:79], v83 offset:45568
    v_mfma_f32_16x16x32_bf16 v[224:227], v[156:159], v[156:159], v[224:227]
    s_waitcnt lgkmcnt(9)
    s_waitcnt vmcnt(5)
    s_barrier
    s_cmp_lg_u32 s50, 0
    s_cbranch_scc1 Lpub_6
    s_mov_b64 exec, 0xffff
    v_mov_b32 v8, s51
    v_lshlrev_b32 v9, 2, v1
    s_add_u32 s95, s92, 18251776
    buffer_store_dword v8, v9, s[40:43], s95 offen sc1
    s_mov_b64 exec, -1
Lpub_6:
    v_mfma_f32_16x16x32_bf16 v[188:191], a[48:51], v[160:163], v[188:191]
    ds_read_b128 v[156:159], v72 offset:52224
    v_mfma_f32_16x16x32_bf16 v[192:195], a[52:55], v[160:163], v[192:195]
    ds_read_b64_tr_b16 a[32:33], v80 offset:49152
    v_mfma_f32_16x16x32_bf16 v[196:199], a[56:59], v[160:163], v[196:199]
    ds_read_b64_tr_b16 a[34:35], v80 offset:49664
    v_mfma_f32_16x16x32_bf16 v[200:203], a[60:63], v[160:163], v[200:203]
    ds_read_b64_tr_b16 a[36:37], v81 offset:49152
    v_mfma_f32_16x16x32_bf16 v[204:207], a[48:51], a[0:3], v[204:207]
    ds_read_b64_tr_b16 a[38:39], v81 offset:49664
    v_mfma_f32_16x16x32_bf16 v[208:211], a[52:55], a[0:3], v[208:211]
    ds_read_b64_tr_b16 a[40:41], v82 offset:49152
    v_mfma_f32_16x16x32_bf16 v[212:215], a[56:59], a[0:3], v[212:215]
    ds_read_b64_tr_b16 a[42:43], v82 offset:49664
    v_mfma_f32_16x16x32_bf16 v[216:219], a[60:63], a[0:3], v[216:219]
    ds_read_b64_tr_b16 a[44:45], v83 offset:49152
    v_mfma_f32_16x16x32_bf16 v[220:223], a[0:3], v[160:163], v[220:223]
    ds_read_b64_tr_b16 a[46:47], v83 offset:49664
    v_mfma_f32_16x16x32_bf16 v[224:227], v[160:163], v[160:163], v[224:227]
    s_waitcnt lgkmcnt(9)
    v_mfma_f32_16x16x32_bf16 v[188:191], a[64:67], v[164:167], v[188:191]
    ds_read_b128 v[160:163], v73 offset:52224
    v_mfma_f32_16x16x32_bf16 v[192:195], a[68:71], v[164:167], v[192:195]
    ds_read_b64_tr_b16 a[48:49], v80 offset:53248
    v_mfma_f32_16x16x32_bf16 v[196:199], a[72:75], v[164:167], v[196:199]
    ds_read_b64_tr_b16 a[50:51], v80 offset:53760
    v_mfma_f32_16x16x32_bf16 v[200:203], a[76:79], v[164:167], v[200:203]
    ds_read_b64_tr_b16 a[52:53], v81 offset:53248
    v_mfma_f32_16x16x32_bf16 v[204:207], a[64:67], a[0:3], v[204:207]
    ds_read_b64_tr_b16 a[54:55], v81 offset:53760
    v_mfma_f32_16x16x32_bf16 v[208:211], a[68:71], a[0:3], v[208:211]
    ds_read_b64_tr_b16 a[56:57], v82 offset:53248
    v_mfma_f32_16x16x32_bf16 v[212:215], a[72:75], a[0:3], v[212:215]
    ds_read_b64_tr_b16 a[58:59], v82 offset:53760
    v_mfma_f32_16x16x32_bf16 v[216:219], a[76:79], a[0:3], v[216:219]
    ds_read_b64_tr_b16 a[60:61], v83 offset:53248
    v_mfma_f32_16x16x32_bf16 v[220:223], a[0:3], v[164:167], v[220:223]
    ds_read_b64_tr_b16 a[62:63], v83 offset:53760
    v_mfma_f32_16x16x32_bf16 v[224:227], v[164:167], v[164:167], v[224:227]
    s_waitcnt lgkmcnt(9)
    v_mfma_f32_16x16x32_bf16 v[188:191], a[32:35], v[156:159], v[188:191]
    ds_read_b128 v[164:167], v74 offset:52224
    v_mfma_f32_16x16x32_bf16 v[192:195], a[36:39], v[156:159], v[192:195]
    ds_read_b64_tr_b16 a[64:65], v80 offset:57344
    v_mfma_f32_16x16x32_bf16 v[196:199], a[40:43], v[156:159], v[196:199]
    ds_read_b64_tr_b16 a[66:67], v80 offset:57856
    v_mfma_f32_16x16x32_bf16 v[200:203], a[44:47], v[156:159], v[200:203]
    ds_read_b64_tr_b16 a[68:69], v81 offset:57344
    v_mfma_f32_16x16x32_bf16 v[204:207], a[32:35], a[0:3], v[204:207]
    ds_read_b64_tr_b16 a[70:71], v81 offset:57856
    v_mfma_f32_16x16x32_bf16 v[208:211], a[36:39], a[0:3], v[208:211]
    ds_read_b64_tr_b16 a[72:73], v82 offset:57344
    v_mfma_f32_16x16x32_bf16 v[212:215], a[40:43], a[0:3], v[212:215]
    ds_read_b64_tr_b16 a[74:75], v82 offset:57856
    v_mfma_f32_16x16x32_bf16 v[216:219], a[44:47], a[0:3], v[216:219]
    ds_read_b64_tr_b16 a[76:77], v83 offset:57344
    v_mfma_f32_16x16x32_bf16 v[220:223], a[0:3], v[156:159], v[220:223]
    ds_read_b64_tr_b16 a[78:79], v83 offset:57856
    v_mfma_f32_16x16x32_bf16 v[224:227], v[156:159], v[156:159], v[224:227]
    s_waitcnt lgkmcnt(9)
    v_mfma_f32_16x16x32_bf16 v[188:191], a[48:51], v[160:163], v[188:191]
    ds_read_b128 v[156:159], v75 offset:52224
    v_mfma_f32_16x16x32_bf16 v[192:195], a[52:55], v[160:163], v[192:195]
    ds_read_b64_tr_b16 a[32:33], v80 offset:61440
    v_mfma_f32_16x16x32_bf16 v[196:199], a[56:59], v[160:163], v[196:199]
    ds_read_b64_tr_b16 a[34:35], v80 offset:61952
    v_mfma_f32_16x16x32_bf16 v[200:203], a[60:63], v[160:163], v[200:203]
    ds_read_b64_tr_b16 a[36:37], v81 offset:61440
    v_mfma_f32_16x16x32_bf16 v[204:207], a[48:51], a[0:3], v[204:207]
    ds_read_b64_tr_b16 a[38:39], v81 offset:61952
    v_mfma_f32_16x16x32_bf16 v[208:211], a[52:55], a[0:3], v[208:211]
    ds_read_b64_tr_b16 a[40:41], v82 offset:61440
    v_mfma_f32_16x16x32_bf16 v[212:215], a[56:59], a[0:3], v[212:215]
    ds_read_b64_tr_b16 a[42:43], v82 offset:61952
    v_mfma_f32_16x16x32_bf16 v[216:219], a[60:63], a[0:3], v[216:219]
    ds_read_b64_tr_b16 a[44:45], v83 offset:61440
    v_mfma_f32_16x16x32_bf16 v[220:223], a[0:3], v[160:163], v[220:223]
    ds_read_b64_tr_b16 a[46:47], v83 offset:61952
    v_mfma_f32_16x16x32_bf16 v[224:227], v[160:163], v[160:163], v[224:227]
    s_waitcnt lgkmcnt(9)
    v_mfma_f32_16x16x32_bf16 v[188:191], a[64:67], v[164:167], v[188:191]
    v_mfma_f32_16x16x32_bf16 v[192:195], a[68:71], v[164:167], v[192:195]
    v_mfma_f32_16x16x32_bf16 v[196:199], a[72:75], v[164:167], v[196:199]
    v_mfma_f32_16x16x32_bf16 v[200:203], a[76:79], v[164:167], v[200:203]
    v_mfma_f32_16x16x32_bf16 v[204:207], a[64:67], a[0:3], v[204:207]
    v_mfma_f32_16x16x32_bf16 v[208:211], a[68:71], a[0:3], v[208:211]
    v_mfma_f32_16x16x32_bf16 v[212:215], a[72:75], a[0:3], v[212:215]
    v_mfma_f32_16x16x32_bf16 v[216:219], a[76:79], a[0:3], v[216:219]
    v_mfma_f32_16x16x32_bf16 v[220:223], a[0:3], v[164:167], v[220:223]
    v_mfma_f32_16x16x32_bf16 v[224:227], v[164:167], v[164:167], v[224:227]
    s_waitcnt lgkmcnt(0)
    v_mfma_f32_16x16x32_bf16 v[188:191], a[32:35], v[156:159], v[188:191]
    v_mfma_f32_16x16x32_bf16 v[192:195], a[36:39], v[156:159], v[192:195]
    v_mfma_f32_16x16x32_bf16 v[196:199], a[40:43], v[156:159], v[196:199]
    v_mfma_f32_16x16x32_bf16 v[200:203], a[44:47], v[156:159], v[200:203]
    v_mfma_f32_16x16x32_bf16 v[204:207], a[32:35], a[0:3], v[204:207]
    v_mfma_f32_16x16x32_bf16 v[208:211], a[36:39], a[0:3], v[208:211]
    v_mfma_f32_16x16x32_bf16 v[212:215], a[40:43], a[0:3], v[212:215]
    v_mfma_f32_16x16x32_bf16 v[216:219], a[44:47], a[0:3], v[216:219]
    v_mfma_f32_16x16x32_bf16 v[220:223], a[0:3], v[156:159], v[220:223]
    v_mfma_f32_16x16x32_bf16 v[224:227], v[156:159], v[156:159], v[224:227]
    s_add_u32 s20, s40, s74
    s_addc_u32 s21, s41, 0
    s_add_u32 s22, s40, s75
    s_addc_u32 s23, s41, 0
    s_mov_b32 s10, s51
    s_mov_b32 s11, s51
    s_mov_b32 s58, 0xaaaaaaaa
    s_mov_b32 s59, s58
    s_mov_b32 s60, 0xcccccccc
    s_mov_b32 s61, s60
    s_mov_b32 vcc_lo, 0x00f0000f
    s_mov_b32 vcc_hi, 0xf0000f00
    v_mul_f32 v176, 0x3b000000, v220
    v_cndmask_b32 v224, v224, v225, s[58:59]
    v_cndmask_b32 v226, v226, v227, s[58:59]
    v_cndmask_b32 v224, v224, v226, s[60:61]
    v_cndmask_b32 v224, 0, v224, vcc
    v_mov_b32 v225, v224
    s_nop 1
    v_permlane16_swap_b32 v224, v225
    v_add_f32 v224, v224, v225
    v_mov_b32 v225, v224
    s_nop 1
    v_permlane32_swap_b32 v224, v225
    v_add_f32 v224, v224, v225
    v_mul_f32 v177, 0x3b000000, v224
    v_fma_f32 v177, -v176, v176, v177
    v_max_f32 v177, 0, v177
    v_add_f32 v179, 0x3727c5ac, v177
    v_rsq_f32 v179, v179
    v_pk_fma_f32 v[188:189], v[204:205], v[176:177], v[188:189] op_sel_hi:[1,0,1] neg_lo:[0,1,0] neg_hi:[0,1,0]
    v_mul_f32 v181, v177, v179
    v_pk_fma_f32 v[190:191], v[206:207], v[176:177], v[190:191] op_sel_hi:[1,0,1] neg_lo:[0,1,0] neg_hi:[0,1,0]
    v_mov_b32 v183, 0x3727c5ac
    v_fma_f32 v181, v181, v179, v183
    v_pk_fma_f32 v[192:193], v[208:209], v[176:177], v[192:193] op_sel_hi:[1,0,1] neg_lo:[0,1,0] neg_hi:[0,1,0]
    v_rsq_f32 v181, v181
    v_pk_fma_f32 v[194:195], v[210:211], v[176:177], v[194:195] op_sel_hi:[1,0,1] neg_lo:[0,1,0] neg_hi:[0,1,0]
    v_pk_fma_f32 v[196:197], v[212:213], v[176:177], v[196:197] op_sel_hi:[1,0,1] neg_lo:[0,1,0] neg_hi:[0,1,0]
    v_mul_f32 v181, v181, v179
    v_pk_fma_f32 v[198:199], v[214:215], v[176:177], v[198:199] op_sel_hi:[1,0,1] neg_lo:[0,1,0] neg_hi:[0,1,0]
    v_pk_fma_f32 v[200:201], v[216:217], v[176:177], v[200:201] op_sel_hi:[1,0,1] neg_lo:[0,1,0] neg_hi:[0,1,0]
    v_pk_fma_f32 v[202:203], v[218:219], v[176:177], v[202:203] op_sel_hi:[1,0,1] neg_lo:[0,1,0] neg_hi:[0,1,0]
    v_rcp_f32 v182, v181
    v_mul_f32 v180, v181, v181
    v_mul_f32 v180, v180, v181
    v_mul_f32 v180, 0xbdd2d3e8, v180
    v_mul_f32 v178, 0xc0135761, v181
    v_pk_mul_f32 v[204:205], v[188:189], v[188:189]
    v_pk_mul_f32 v[206:207], v[190:191], v[190:191]
    v_pk_mul_f32 v[208:209], v[192:193], v[192:193]
    v_pk_mul_f32 v[210:211], v[194:195], v[194:195]
    v_pk_fma_f32 v[204:205], v[204:205], v[180:181], v[178:179] op_sel_hi:[1,0,0]
    v_pk_fma_f32 v[206:207], v[206:207], v[180:181], v[178:179] op_sel_hi:[1,0,0]
    v_pk_fma_f32 v[208:209], v[208:209], v[180:181], v[178:179] op_sel_hi:[1,0,0]
    v_pk_fma_f32 v[210:211], v[210:211], v[180:181], v[178:179] op_sel_hi:[1,0,0]
    v_pk_mul_f32 v[204:205], v[204:205], v[188:189]
    v_pk_mul_f32 v[206:207], v[206:207], v[190:191]
    v_pk_mul_f32 v[208:209], v[208:209], v[192:193]
    v_pk_mul_f32 v[210:211], v[210:211], v[194:195]
    v_exp_f32 v204, v204
    v_exp_f32 v206, v206
    v_exp_f32 v208, v208
    v_exp_f32 v210, v210
    v_exp_f32 v205, v205
    v_exp_f32 v207, v207
    v_exp_f32 v209, v209
    v_exp_f32 v211, v211
    v_pk_fma_f32 v[204:205], v[204:205], v[182:183], v[182:183] op_sel_hi:[1,0,0]
    v_pk_fma_f32 v[206:207], v[206:207], v[182:183], v[182:183] op_sel_hi:[1,0,0]
    v_pk_fma_f32 v[208:209], v[208:209], v[182:183], v[182:183] op_sel_hi:[1,0,0]
    v_pk_fma_f32 v[210:211], v[210:211], v[182:183], v[182:183] op_sel_hi:[1,0,0]
    v_rcp_f32 v204, v204
    v_rcp_f32 v206, v206
    v_rcp_f32 v208, v208
    v_rcp_f32 v210, v210
    v_rcp_f32 v205, v205
    v_rcp_f32 v207, v207
    v_rcp_f32 v209, v209
    v_rcp_f32 v211, v211
    v_pk_mul_f32 v[188:189], v[188:189], v[204:205]
    v_pk_mul_f32 v[190:191], v[190:191], v[206:207]
    v_pk_mul_f32 v[192:193], v[192:193], v[208:209]
    v_pk_mul_f32 v[194:195], v[194:195], v[210:211]
    v_cvt_pk_bf16_f32 v156, v188, v189
    v_cvt_pk_bf16_f32 v157, v190, v191
    v_cvt_pk_bf16_f32 v158, v192, v193
    v_cvt_pk_bf16_f32 v159, v194, v195
    v_pk_mul_f32 v[212:213], v[196:197], v[196:197]
    v_pk_mul_f32 v[214:215], v[198:199], v[198:199]
    v_pk_mul_f32 v[216:217], v[200:201], v[200:201]
    v_pk_mul_f32 v[218:219], v[202:203], v[202:203]
    v_pk_fma_f32 v[212:213], v[212:213], v[180:181], v[178:179] op_sel_hi:[1,0,0]
    v_pk_fma_f32 v[214:215], v[214:215], v[180:181], v[178:179] op_sel_hi:[1,0,0]
    v_pk_fma_f32 v[216:217], v[216:217], v[180:181], v[178:179] op_sel_hi:[1,0,0]
    v_pk_fma_f32 v[218:219], v[218:219], v[180:181], v[178:179] op_sel_hi:[1,0,0]
    v_pk_mul_f32 v[212:213], v[212:213], v[196:197]
    v_pk_mul_f32 v[214:215], v[214:215], v[198:199]
    v_pk_mul_f32 v[216:217], v[216:217], v[200:201]
    v_pk_mul_f32 v[218:219], v[218:219], v[202:203]
    v_exp_f32 v212, v212
    v_exp_f32 v214, v214
    v_exp_f32 v216, v216
    v_exp_f32 v218, v218
    v_exp_f32 v213, v213
    v_exp_f32 v215, v215
    v_exp_f32 v217, v217
    v_exp_f32 v219, v219
    v_pk_fma_f32 v[212:213], v[212:213], v[182:183], v[182:183] op_sel_hi:[1,0,0]
    v_pk_fma_f32 v[214:215], v[214:215], v[182:183], v[182:183] op_sel_hi:[1,0,0]
    v_pk_fma_f32 v[216:217], v[216:217], v[182:183], v[182:183] op_sel_hi:[1,0,0]
    v_pk_fma_f32 v[218:219], v[218:219], v[182:183], v[182:183] op_sel_hi:[1,0,0]
    v_rcp_f32 v212, v212
    v_rcp_f32 v214, v214
    v_rcp_f32 v216, v216
    v_rcp_f32 v218, v218
    v_rcp_f32 v213, v213
    v_rcp_f32 v215, v215
    v_rcp_f32 v217, v217
    v_rcp_f32 v219, v219
    v_pk_mul_f32 v[196:197], v[196:197], v[212:213]
    v_pk_mul_f32 v[198:199], v[198:199], v[214:215]
    v_pk_mul_f32 v[200:201], v[200:201], v[216:217]
    v_pk_mul_f32 v[202:203], v[202:203], v[218:219]
    v_cvt_pk_bf16_f32 v160, v196, v197
    v_cvt_pk_bf16_f32 v161, v198, v199
    v_cvt_pk_bf16_f32 v162, v200, v201
    v_cvt_pk_bf16_f32 v163, v202, v203
    buffer_store_dwordx4 v[156:159], v2, s[40:43], s76 offen offset:0 sc1
    buffer_store_dwordx4 v[160:163], v2, s[40:43], s76 offen offset:1024 sc1
    s_barrier
    s_add_u32 m0, s65, 71680
    s_add_u32 s3, s77, 0
    buffer_load_dwordx4 v44, s[24:27], s3 offen offset:0 lds
    s_lshl_b32 s52, s50, 12
    v_add_u32 v12, s52, v76
    v_add_u32 v13, s52, v77
    v_add_u32 v14, s52, v78
    v_add_u32 v15, s52, v79
    ds_read_b128 v[156:159], v12 offset:0
    ds_read_b128 v[160:163], v13 offset:0
    ds_read_b128 v[164:167], v14 offset:0
    ds_read_b128 v[168:171], v15 offset:0
    ds_read_b128 v[172:175], v12 offset:17408
    ds_read_b128 v[176:179], v13 offset:17408
    s_waitcnt lgkmcnt(4)
    v_mfma_f32_16x16x32_bf16 v[220:223], a[0:3], v[156:159], 0
    ds_read_b64 v[20:21], v68 offset:0
    v_mfma_f32_16x16x32_bf16 v[224:227], v[156:159], v[156:159], 0
    ds_read_b128 v[180:183], v14 offset:17408
    v_mfma_f32_16x16x32_bf16 v[220:223], a[0:3], v[160:163], v[220:223]
    buffer_load_dwordx4 v45, s[24:27], s3 offen offset:1024 lds
    v_mfma_f32_16x16x32_bf16 v[224:227], v[160:163], v[160:163], v[224:227]
    ds_read_b128 v[184:187], v15 offset:17408
    s_waitcnt lgkmcnt(5)
    v_mfma_f32_16x16x32_bf16 v[220:223], a[0:3], v[164:167], v[220:223]
    ds_read_b64 v[22:23], v69 offset:0
    v_mfma_f32_16x16x32_bf16 v[224:227], v[164:167], v[164:167], v[224:227]
    ds_read_b128 v[156:159], v12 offset:34816
    v_mfma_f32_16x16x32_bf16 v[220:223], a[0:3], v[168:171], v[220:223]
    buffer_load_dwordx4 v46, s[24:27], s3 offen offset:2048 lds
    v_mfma_f32_16x16x32_bf16 v[224:227], v[168:171], v[168:171], v[224:227]
    ds_read_b128 v[160:163], v13 offset:34816
    s_waitcnt lgkmcnt(6)
    v_mfma_f32_16x16x32_bf16 v[220:223], a[0:3], v[172:175], v[220:223]
    ds_read_b64 v[24:25], v70 offset:0
    v_mfma_f32_16x16x32_bf16 v[224:227], v[172:175], v[172:175], v[224:227]
    ds_read_b128 v[164:167], v14 offset:34816
    v_mfma_f32_16x16x32_bf16 v[220:223], a[0:3], v[176:179], v[220:223]
    buffer_load_dwordx4 v47, s[24:27], s3 offen offset:3072 lds
    v_mfma_f32_16x16x32_bf16 v[224:227], v[176:179], v[176:179], v[224:227]
    ds_read_b128 v[168:171], v15 offset:34816
    s_waitcnt lgkmcnt(6)
    v_mfma_f32_16x16x32_bf16 v[220:223], a[0:3], v[180:183], v[220:223]
    ds_read_b64 v[26:27], v71 offset:0
    v_mfma_f32_16x16x32_bf16 v[224:227], v[180:183], v[180:183], v[224:227]
    ds_read_b128 v[172:175], v12 offset:52224
    v_mfma_f32_16x16x32_bf16 v[220:223], a[0:3], v[184:187], v[220:223]
    s_add_u32 m0, s65, 75776
    s_add_u32 s3, s77, 32768
    buffer_load_dwordx4 v44, s[24:27], s3 offen offset:0 lds
    v_mfma_f32_16x16x32_bf16 v[224:227], v[184:187], v[184:187], v[224:227]
    ds_read_b128 v[176:179], v13 offset:52224
    s_waitcnt lgkmcnt(6)
    v_mfma_f32_16x16x32_bf16 v[220:223], a[0:3], v[156:159], v[220:223]
    v_mfma_f32_16x16x32_bf16 v[224:227], v[156:159], v[156:159], v[224:227]
    ds_read_b128 v[180:183], v14 offset:52224
    v_mfma_f32_16x16x32_bf16 v[220:223], a[0:3], v[160:163], v[220:223]
    buffer_load_dwordx4 v45, s[24:27], s3 offen offset:1024 lds
    v_mfma_f32_16x16x32_bf16 v[224:227], v[160:163], v[160:163], v[224:227]
    ds_read_b128 v[184:187], v15 offset:52224
    s_waitcnt lgkmcnt(5)
    v_mfma_f32_16x16x32_bf16 v[220:223], a[0:3], v[164:167], v[220:223]
    v_mfma_f32_16x16x32_bf16 v[224:227], v[164:167], v[164:167], v[224:227]
    ds_read_b128 a[144:147], v76 offset:0
    s_add_u32 s57, s75, 163840
    v_and_b32 v11, 7, v1
    v_lshlrev_b32 v11, 10, v11
    buffer_load_dword v4, v11, s[40:43], s57 offen sc1
    v_mfma_f32_16x16x32_bf16 v[220:223], a[0:3], v[168:171], v[220:223]
    buffer_load_dwordx4 v46, s[24:27], s3 offen offset:2048 lds
    v_mfma_f32_16x16x32_bf16 v[224:227], v[168:171], v[168:171], v[224:227]
    ds_read_b128 a[148:151], v76 offset:4096
    s_waitcnt lgkmcnt(4)
    v_mfma_f32_16x16x32_bf16 v[220:223], a[0:3], v[172:175], v[220:223]
    v_mfma_f32_16x16x32_bf16 v[224:227], v[172:175], v[172:175], v[224:227]
    ds_read_b128 a[152:155], v76 offset:8192
    v_mfma_f32_16x16x32_bf16 v[220:223], a[0:3], v[176:179], v[220:223]
    buffer_load_dwordx4 v47, s[24:27], s3 offen offset:3072 lds
    v_mfma_f32_16x16x32_bf16 v[224:227], v[176:179], v[176:179], v[224:227]
    ds_read_b128 a[156:159], v76 offset:12288
    s_waitcnt lgkmcnt(4)
    v_mfma_f32_16x16x32_bf16 v[220:223], a[0:3], v[180:183], v[220:223]
    v_mfma_f32_16x16x32_bf16 v[224:227], v[180:183], v[180:183], v[224:227]
    ds_read_b128 a[160:163], v77 offset:0
    v_mfma_f32_16x16x32_bf16 v[220:223], a[0:3], v[184:187], v[220:223]
    s_add_u32 m0, s65, 79872
    s_add_u32 s3, s77, 65536
    buffer_load_dwordx4 v44, s[24:27], s3 offen offset:0 lds
    v_mfma_f32_16x16x32_bf16 v[224:227], v[184:187], v[184:187], v[224:227]
    ds_read_b128 a[164:167], v77 offset:4096
    ds_read_b128 a[168:171], v77 offset:8192
    ds_read_b128 a[172:175], v77 offset:12288
    ds_read_b128 a[176:179], v78 offset:0
    ds_read_b128 a[180:183], v78 offset:4096
    s_mov_b32 s58, 0xaaaaaaaa
    s_mov_b32 s59, s58
    s_mov_b32 s60, 0xcccccccc
    s_mov_b32 s61, s60
    s_mov_b32 vcc_lo, 0x00f0000f
    s_mov_b32 vcc_hi, 0xf0000f00
    v_mul_f32 v48, 0x3b000000, v220
    v_cndmask_b32 v224, v224, v225, s[58:59]
    v_cndmask_b32 v226, v226, v227, s[58:59]
    v_cndmask_b32 v224, v224, v226, s[60:61]
    v_cndmask_b32 v224, 0, v224, vcc
    v_mov_b32 v225, v224
    s_nop 1
    v_permlane16_swap_b32 v224, v225
    v_add_f32 v224, v224, v225
    v_mov_b32 v225, v224
    s_nop 1
    v_permlane32_swap_b32 v224, v225
    v_add_f32 v224, v224, v225
    v_mul_f32 v49, 0x3b000000, v224
    v_fma_f32 v49, -v48, v48, v49
    v_max_f32 v49, 0, v49
    v_add_f32 v49, 0x3727c5ac, v49
    v_rsq_f32 v49, v49
    s_lshl_b32 s52, s50, 6
    s_add_u32 s52, s52, 69632
    v_lshl_add_u32 v12, v10, 2, s52
    ds_write_b32 v12, v49
    buffer_load_dwordx4 v45, s[24:27], s3 offen offset:1024 lds
    v_mul_f32 v48, v48, v49
    v_lshlrev_b32 v28, 16, v20
    v_and_b32 v29, 0xffff0000, v20
    v_lshlrev_b32 v30, 16, v21
    v_and_b32 v31, 0xffff0000, v21
    v_lshlrev_b32 v32, 16, v22
    v_and_b32 v33, 0xffff0000, v22
    v_lshlrev_b32 v34, 16, v23
    v_and_b32 v35, 0xffff0000, v23
    v_lshlrev_b32 v36, 16, v24
    v_and_b32 v37, 0xffff0000, v24
    v_lshlrev_b32 v38, 16, v25
    v_and_b32 v39, 0xffff0000, v25
    v_lshlrev_b32 v40, 16, v26
    v_and_b32 v41, 0xffff0000, v26
    v_lshlrev_b32 v42, 16, v27
    v_and_b32 v43, 0xffff0000, v27
    buffer_load_dwordx4 v46, s[24:27], s3 offen offset:2048 lds
    v_pk_fma_f32 v[28:29], v[28:29], v[48:49], v[48:49] op_sel:[0,1,0] op_sel_hi:[1,1,0] neg_lo:[0,0,1] neg_hi:[0,0,1]
    v_pk_fma_f32 v[30:31], v[30:31], v[48:49], v[48:49] op_sel:[0,1,0] op_sel_hi:[1,1,0] neg_lo:[0,0,1] neg_hi:[0,0,1]
    v_pk_fma_f32 v[32:33], v[32:33], v[48:49], v[48:49] op_sel:[0,1,0] op_sel_hi:[1,1,0] neg_lo:[0,0,1] neg_hi:[0,0,1]
    v_pk_fma_f32 v[34:35], v[34:35], v[48:49], v[48:49] op_sel:[0,1,0] op_sel_hi:[1,1,0] neg_lo:[0,0,1] neg_hi:[0,0,1]
    v_pk_fma_f32 v[36:37], v[36:37], v[48:49], v[48:49] op_sel:[0,1,0] op_sel_hi:[1,1,0] neg_lo:[0,0,1] neg_hi:[0,0,1]
    v_pk_fma_f32 v[38:39], v[38:39], v[48:49], v[48:49] op_sel:[0,1,0] op_sel_hi:[1,1,0] neg_lo:[0,0,1] neg_hi:[0,0,1]
    v_pk_fma_f32 v[40:41], v[40:41], v[48:49], v[48:49] op_sel:[0,1,0] op_sel_hi:[1,1,0] neg_lo:[0,0,1] neg_hi:[0,0,1]
    v_pk_fma_f32 v[42:43], v[42:43], v[48:49], v[48:49] op_sel:[0,1,0] op_sel_hi:[1,1,0] neg_lo:[0,0,1] neg_hi:[0,0,1]
    s_mov_b32 s56, 0
    s_waitcnt vmcnt(5)
    v_cmp_ne_u32 vcc, s51, v4
    s_nop 0
    s_cbranch_vccz Ldone_9
Lpoll_8:
    s_sleep 4
    buffer_load_dword v4, v11, s[40:43], s57 offen sc1
    s_add_u32 s56, s56, 1
    s_cmp_gt_u32 s56, 0x40000
    s_cbranch_scc1 Ldone_9
    s_waitcnt vmcnt(0)
    v_cmp_ne_u32 vcc, s51, v4
    s_nop 0
    s_cbranch_vccz Ldone_9
    s_branch Lpoll_8
Ldone_9:
    s_waitcnt lgkmcnt(0)
    s_barrier
    s_cmp_lg_u32 s50, 0
    s_cbranch_scc1 Lpub_11
    s_mov_b64 exec, 0xffff
    v_mov_b32 v8, s51
    v_lshlrev_b32 v9, 2, v1
    s_add_u32 s95, s92, 18087936
    buffer_store_dword v8, v9, s[40:43], s95 offen sc1
    s_mov_b64 exec, -1
Lpub_11:
    v_mfma_f32_16x16x32_bf16 v[188:191], a[144:147], v[84:87], 0
    ds_read_b128 a[184:187], v78 offset:8192
    s_add_u32 s60, s66, 145408
    v_mfma_f32_16x16x32_bf16 v[192:195], a[148:151], v[84:87], 0
    ds_read_b128 a[188:191], v78 offset:12288
    v_add_u32 v16, s60, v2
    v_mfma_f32_16x16x32_bf16 v[196:199], a[152:155], v[84:87], 0
    ds_read_b128 a[144:147], v79 offset:0
    buffer_load_dwordx4 v47, s[24:27], s3 offen offset:3072 lds
    v_mfma_f32_16x16x32_bf16 v[200:203], a[156:159], v[84:87], 0
    ds_read_b128 a[148:151], v79 offset:4096
    ds_write_b128 v16, v[148:151]
    v_mfma_f32_16x16x32_bf16 v[188:191], a[160:163], v[88:91], v[188:191]
    ds_read_b128 a[152:155], v79 offset:8192
    ds_write_b128 v16, v[152:155] offset:1024
    v_mfma_f32_16x16x32_bf16 v[192:195], a[164:167], v[88:91], v[192:195]
    ds_read_b128 a[156:159], v79 offset:12288
    ds_read_b64_tr_b16 v[148:149], v62 offset:0
    v_mfma_f32_16x16x32_bf16 v[196:199], a[168:171], v[88:91], v[196:199]
    ds_read_b128 a[160:163], v76 offset:17408
    s_add_u32 m0, s65, 83968
    s_add_u32 s3, s77, 98304
    buffer_load_dwordx4 v44, s[24:27], s3 offen offset:0 lds
    v_mfma_f32_16x16x32_bf16 v[200:203], a[172:175], v[88:91], v[200:203]
    ds_read_b128 a[164:167], v76 offset:21504
    ds_read_b64_tr_b16 v[150:151], v62 offset:1024
    s_waitcnt lgkmcnt(10)
    v_mfma_f32_16x16x32_bf16 v[188:191], a[176:179], v[92:95], v[188:191]
    ds_read_b128 a[168:171], v76 offset:25600
    ds_read_b64_tr_b16 v[152:153], v62 offset:32
    v_mfma_f32_16x16x32_bf16 v[192:195], a[180:183], v[92:95], v[192:195]
    ds_read_b128 a[172:175], v76 offset:29696
    ds_read_b64_tr_b16 v[154:155], v62 offset:1056
    v_mfma_f32_16x16x32_bf16 v[196:199], a[184:187], v[92:95], v[196:199]
    ds_read_b128 a[176:179], v77 offset:17408
    buffer_load_dwordx4 v45, s[24:27], s3 offen offset:1024 lds
    v_mfma_f32_16x16x32_bf16 v[200:203], a[188:191], v[92:95], v[200:203]
    ds_read_b128 a[180:183], v77 offset:21504
    s_add_u32 s60, s78, 131072
    s_waitcnt lgkmcnt(10)
    v_mfma_f32_16x16x32_bf16 v[188:191], a[144:147], v[96:99], v[188:191]
    ds_read_b128 a[184:187], v77 offset:25600
    s_waitcnt lgkmcnt(7)
    buffer_store_dwordx4 v[148:151], v63, s[40:43], s78 offen sc1
    v_mfma_f32_16x16x32_bf16 v[192:195], a[148:151], v[96:99], v[192:195]
    ds_read_b128 a[188:191], v77 offset:29696
    s_waitcnt lgkmcnt(4)
    buffer_store_dwordx4 v[152:155], v63, s[40:43], s60 offen sc1
    v_mfma_f32_16x16x32_bf16 v[196:199], a[152:155], v[96:99], v[196:199]
    ds_read_b128 a[144:147], v78 offset:17408
    buffer_load_dwordx4 v46, s[24:27], s3 offen offset:2048 lds
    v_mfma_f32_16x16x32_bf16 v[200:203], a[156:159], v[96:99], v[200:203]
    ds_read_b128 a[148:151], v78 offset:21504
    ds_read_b64_tr_b16 a[128:129], v60
    v_mfma_f32_16x16x32_bf16 v[188:191], a[160:163], v[100:103], v[188:191]
    ds_read_b128 a[152:155], v78 offset:25600
    ds_read_b64_tr_b16 a[130:131], v60 offset:1024
    v_mfma_f32_16x16x32_bf16 v[192:195], a[164:167], v[100:103], v[192:195]
    ds_read_b128 a[156:159], v78 offset:29696
    ds_read_b64_tr_b16 a[132:133], v61
    v_mfma_f32_16x16x32_bf16 v[196:199], a[168:171], v[100:103], v[196:199]
    ds_read_b128 a[160:163], v79 offset:17408
    buffer_load_dwordx4 v47, s[24:27], s3 offen offset:3072 lds
    v_mfma_f32_16x16x32_bf16 v[200:203], a[172:175], v[100:103], v[200:203]
    ds_read_b128 a[164:167], v79 offset:21504
    ds_read_b64_tr_b16 a[134:135], v61 offset:1024
    s_waitcnt lgkmcnt(10)
    v_mfma_f32_16x16x32_bf16 v[188:191], a[176:179], v[104:107], v[188:191]
    ds_read_b128 a[168:171], v79 offset:25600
    s_waitcnt lgkmcnt(6)
    buffer_store_dwordx4 a[128:131], v2, s[40:43], s79 offen sc1
    v_mfma_f32_16x16x32_bf16 v[192:195], a[180:183], v[104:107], v[192:195]
    ds_read_b128 a[172:175], v79 offset:29696
    s_waitcnt lgkmcnt(2)
    buffer_store_dwordx4 a[132:135], v2, s[40:43], s79 offen offset:1024 sc1
    v_mfma_f32_16x16x32_bf16 v[196:199], a[184:187], v[104:107], v[196:199]
    ds_read_b128 a[176:179], v76 offset:34816
    s_add_u32 s3, s69, 0
    buffer_load_dwordx4 a[0:3], v2, s[40:43], s3 offen offset:0 sc1
    v_mfma_f32_16x16x32_bf16 v[200:203], a[188:191], v[104:107], v[200:203]
    ds_read_b128 a[180:183], v76 offset:38912
    v_lshlrev_b32 v12, 4, v3
    v_mfma_f32_16x16x32_bf16 v[188:191], a[144:147], v[108:111], v[188:191]
    ds_read_b128 a[184:187], v76 offset:43008
    v_add_u32 v12, 69632, v12
    v_mfma_f32_16x16x32_bf16 v[192:195], a[148:151], v[108:111], v[192:195]
    ds_read_b128 a[188:191], v76 offset:47104
    ds_read_b128 v[204:207], v12 offset:0
    v_mfma_f32_16x16x32_bf16 v[196:199], a[152:155], v[108:111], v[196:199]
    ds_read_b128 a[144:147], v77 offset:34816
    buffer_load_dwordx4 a[4:7], v2, s[40:43], s3 offen offset:1024 sc1
    v_mfma_f32_16x16x32_bf16 v[200:203], a[156:159], v[108:111], v[200:203]
    ds_read_b128 a[148:151], v77 offset:38912
    ds_read_b128 v[208:211], v12 offset:64
    s_waitcnt lgkmcnt(8)
    v_mfma_f32_16x16x32_bf16 v[188:191], a[160:163], v[112:115], v[188:191]
    ds_read_b128 a[152:155], v77 offset:43008
    ds_read_b128 v[212:215], v12 offset:128
    v_mfma_f32_16x16x32_bf16 v[192:195], a[164:167], v[112:115], v[192:195]
    ds_read_b128 a[156:159], v77 offset:47104
    ds_read_b128 v[216:219], v12 offset:192
    v_mfma_f32_16x16x32_bf16 v[196:199], a[168:171], v[112:115], v[196:199]
    ds_read_b128 a[160:163], v78 offset:34816
    buffer_load_dwordx4 a[8:11], v2, s[40:43], s3 offen offset:2048 sc1
    s_mov_b32 s63, 18022400
    v_lshlrev_b32 v224, 6, v0
    buffer_load_dwordx4 v[220:223], v224, s[40:43], s63 offen sc1
    v_mfma_f32_16x16x32_bf16 v[200:203], a[172:175], v[112:115], v[200:203]
    ds_read_b128 a[164:167], v78 offset:38912
    v_lshlrev_b32 v12, 9, v3
    s_waitcnt lgkmcnt(10)
    v_mfma_f32_16x16x32_bf16 v[188:191], a[176:179], v[116:119], v[188:191]
    ds_read_b128 a[168:171], v78 offset:43008
    v_add_u32 v12, 71680, v12
    v_mfma_f32_16x16x32_bf16 v[192:195], a[180:183], v[116:119], v[192:195]
    ds_read_b128 a[172:175], v78 offset:47104
    v_add_u32 v68, v12, v52
    v_mfma_f32_16x16x32_bf16 v[196:199], a[184:187], v[116:119], v[196:199]
    ds_read_b128 a[176:179], v79 offset:34816
    buffer_load_dwordx4 a[12:15], v2, s[40:43], s3 offen offset:3072 sc1
    v_mfma_f32_16x16x32_bf16 v[200:203], a[188:191], v[116:119], v[200:203]
    ds_read_b128 a[180:183], v79 offset:38912
    v_add_u32 v69, v12, v53
    s_waitcnt lgkmcnt(7)
    v_mfma_f32_16x16x32_bf16 v[188:191], a[144:147], v[120:123], v[188:191]
    ds_read_b128 a[184:187], v79 offset:43008
    v_add_u32 v70, v12, v54
    v_mfma_f32_16x16x32_bf16 v[192:195], a[148:151], v[120:123], v[192:195]
    ds_read_b128 a[188:191], v79 offset:47104
    v_add_u32 v71, v12, v55
    v_mfma_f32_16x16x32_bf16 v[196:199], a[152:155], v[120:123], v[196:199]
    ds_read_b128 a[144:147], v76 offset:52224
    s_add_u32 s3, s69, 4096
    buffer_load_dwordx4 a[16:19], v2, s[40:43], s3 offen offset:0 sc1
    v_mfma_f32_16x16x32_bf16 v[200:203], a[156:159], v[120:123], v[200:203]
    ds_read_b128 a[148:151], v76 offset:56320
    v_lshl_add_u32 v19, v10, 6, v58
    s_waitcnt lgkmcnt(6)
    v_mfma_f32_16x16x32_bf16 v[188:191], a[160:163], v[124:127], v[188:191]
    ds_read_b128 a[152:155], v76 offset:60416
    s_add_u32 s57, s74, 0
    v_and_b32 v11, 1, v1
    v_lshlrev_b32 v11, 7, v11
    buffer_load_dword v4, v11, s[40:43], s57 offen sc1
    v_mfma_f32_16x16x32_bf16 v[192:195], a[164:167], v[124:127], v[192:195]
    ds_read_b128 a[156:159], v76 offset:64512
    v_mfma_f32_16x16x32_bf16 v[196:199], a[168:171], v[124:127], v[196:199]
    ds_read_b128 a[160:163], v77 offset:52224
    buffer_load_dwordx4 a[20:23], v2, s[40:43], s3 offen offset:1024 sc1
    v_mfma_f32_16x16x32_bf16 v[200:203], a[172:175], v[124:127], v[200:203]
    ds_read_b128 a[164:167], v77 offset:56320
    s_waitcnt lgkmcnt(6)
    v_mfma_f32_16x16x32_bf16 v[188:191], a[176:179], v[128:131], v[188:191]
    ds_read_b128 a[168:171], v77 offset:60416
    v_mfma_f32_16x16x32_bf16 v[192:195], a[180:183], v[128:131], v[192:195]
    ds_read_b128 a[172:175], v77 offset:64512
    v_mfma_f32_16x16x32_bf16 v[196:199], a[184:187], v[128:131], v[196:199]
    ds_read_b128 a[176:179], v78 offset:52224
    buffer_load_dwordx4 a[24:27], v2, s[40:43], s3 offen offset:2048 sc1
    v_mfma_f32_16x16x32_bf16 v[200:203], a[188:191], v[128:131], v[200:203]
    ds_read_b128 a[180:183], v78 offset:56320
    s_waitcnt lgkmcnt(6)
    v_mfma_f32_16x16x32_bf16 v[188:191], a[144:147], v[132:135], v[188:191]
    ds_read_b128 a[184:187], v78 offset:60416
    v_mfma_f32_16x16x32_bf16 v[192:195], a[148:151], v[132:135], v[192:195]
    ds_read_b128 a[188:191], v78 offset:64512
    v_mfma_f32_16x16x32_bf16 v[196:199], a[152:155], v[132:135], v[196:199]
    ds_read_b128 a[144:147], v79 offset:52224
    v_mfma_f32_16x16x32_bf16 v[200:203], a[156:159], v[132:135], v[200:203]
    ds_read_b128 a[148:151], v79 offset:56320
    s_waitcnt lgkmcnt(6)
    v_mfma_f32_16x16x32_bf16 v[188:191], a[160:163], v[136:139], v[188:191]
    ds_read_b128 a[152:155], v79 offset:60416
    v_mfma_f32_16x16x32_bf16 v[192:195], a[164:167], v[136:139], v[192:195]
    ds_read_b128 a[156:159], v79 offset:64512
    v_mfma_f32_16x16x32_bf16 v[196:199], a[168:171], v[136:139], v[196:199]
    v_mfma_f32_16x16x32_bf16 v[200:203], a[172:175], v[136:139], v[200:203]
    s_waitcnt lgkmcnt(4)
    v_mfma_f32_16x16x32_bf16 v[188:191], a[176:179], v[140:143], v[188:191]
    v_mfma_f32_16x16x32_bf16 v[192:195], a[180:183], v[140:143], v[192:195]
    v_mfma_f32_16x16x32_bf16 v[196:199], a[184:187], v[140:143], v[196:199]
    v_mfma_f32_16x16x32_bf16 v[200:203], a[188:191], v[140:143], v[200:203]
    s_waitcnt lgkmcnt(0)
    v_mfma_f32_16x16x32_bf16 v[188:191], a[144:147], v[144:147], v[188:191]
    v_mfma_f32_16x16x32_bf16 v[192:195], a[148:151], v[144:147], v[192:195]
    v_mfma_f32_16x16x32_bf16 v[196:199], a[152:155], v[144:147], v[196:199]
    v_mfma_f32_16x16x32_bf16 v[200:203], a[156:159], v[144:147], v[200:203]
    s_mov_b32 s56, 0
    s_waitcnt vmcnt(5)
    v_cmp_ne_u32 vcc, s51, v221
    v_cmp_ne_u32 s[58:59], s51, v223
    s_nop 0
    s_or_b64 vcc, vcc, s[58:59]
    s_cbranch_vccz Ldone_14
Lpoll_13:
    s_sleep 4
    buffer_load_dwordx4 v[220:223], v224, s[40:43], s63 offen sc1
    s_waitcnt vmcnt(0)
    s_add_u32 s56, s56, 1
    v_cmp_ne_u32 vcc, s51, v221
    v_cmp_ne_u32 s[58:59], s51, v223
    s_nop 0
    s_or_b64 vcc, vcc, s[58:59]
    s_cbranch_vccz Ldone_14
    s_cmp_lt_u32 s56, 0x40000
    s_cbranch_scc1 Lpoll_13
Ldone_14:
    s_mov_b32 s58, 0x05040100
    s_mov_b32 s59, 0x07060302
    v_perm_b32 v221, v222, v220, s58
    v_perm_b32 v223, v222, v220, s59
    ds_write_b32 v67, v221
    ds_write_b32 v67, v223 offset:1024
    v_pk_mul_f32 v[188:189], v[188:189], v[204:205]
    v_pk_mul_f32 v[190:191], v[190:191], v[206:207]
    v_pk_mul_f32 v[192:193], v[192:193], v[208:209]
    v_pk_mul_f32 v[194:195], v[194:195], v[210:211]
    v_pk_mul_f32 v[196:197], v[196:197], v[212:213]
    v_pk_mul_f32 v[198:199], v[198:199], v[214:215]
    v_pk_mul_f32 v[200:201], v[200:201], v[216:217]
    v_pk_mul_f32 v[202:203], v[202:203], v[218:219]
    v_cvt_pk_bf16_f32 v156, v188, v189
    v_cvt_pk_bf16_f32 v157, v190, v191
    v_cvt_pk_bf16_f32 v158, v192, v193
    v_cvt_pk_bf16_f32 v159, v194, v195
    v_cvt_pk_bf16_f32 v160, v196, v197
    v_cvt_pk_bf16_f32 v161, v198, v199
    v_cvt_pk_bf16_f32 v162, v200, v201
    v_cvt_pk_bf16_f32 v163, v202, v203
    v_permlane16_swap_b32 v156, v158
    v_permlane16_swap_b32 v157, v159
    v_permlane16_swap_b32 v160, v162
    v_permlane16_swap_b32 v161, v163
    buffer_store_dwordx4 v[156:159], v19, s[40:43], s80 offen offset:0 sc1
    buffer_store_dwordx4 v[160:163], v19, s[40:43], s80 offen offset:1024 sc1
    s_mov_b32 s56, 0
    s_waitcnt vmcnt(4)
    v_cmp_ne_u32 vcc, s51, v4
    s_nop 0
    s_cbranch_vccz Ldone_17
Lpoll_16:
    s_sleep 4
    buffer_load_dword v4, v11, s[40:43], s57 offen sc1
    s_add_u32 s56, s56, 1
    s_cmp_gt_u32 s56, 0x40000
    s_cbranch_scc1 Ldone_17
    s_waitcnt vmcnt(0)
    v_cmp_ne_u32 vcc, s51, v4
    s_nop 0
    s_cbranch_vccz Ldone_17
    s_branch Lpoll_16
Ldone_17:
    s_waitcnt lgkmcnt(0)
    s_barrier
    s_add_u32 s52, s64, 0
    buffer_load_dwordx4 a[192:195], v2, s[40:43], s52 offen offset:0 sc1
    buffer_load_dwordx4 a[196:199], v2, s[40:43], s52 offen offset:1024 sc1
    buffer_load_dwordx4 a[200:203], v2, s[40:43], s52 offen offset:2048 sc1
    buffer_load_dwordx4 a[204:207], v2, s[40:43], s52 offen offset:3072 sc1
    s_add_u32 s52, s64, 4096
    buffer_load_dwordx4 a[208:211], v2, s[40:43], s52 offen offset:0 sc1
    buffer_load_dwordx4 a[212:215], v2, s[40:43], s52 offen offset:1024 sc1
    buffer_load_dwordx4 a[216:219], v2, s[40:43], s52 offen offset:2048 sc1
    buffer_load_dwordx4 a[220:223], v2, s[40:43], s52 offen offset:3072 sc1
    ds_read_b128 a[144:147], v66 offset:0
    ds_read_b64_tr_b16 a[128:129], v68 offset:0
    ds_read_b64_tr_b16 a[130:131], v68 offset:2048
    ds_read_b64_tr_b16 a[132:133], v69 offset:0
    ds_read_b64_tr_b16 a[134:135], v69 offset:2048
    ds_read_b64_tr_b16 a[136:137], v70 offset:0
    ds_read_b64_tr_b16 a[138:139], v70 offset:2048
    ds_read_b64_tr_b16 a[140:141], v71 offset:0
    ds_read_b64_tr_b16 a[142:143], v71 offset:2048
    ds_read_b128 a[164:167], v66 offset:64
    ds_read_b64_tr_b16 a[148:149], v68 offset:4096
    ds_read_b64_tr_b16 a[150:151], v68 offset:6144
    ds_read_b64_tr_b16 a[152:153], v69 offset:4096
    ds_read_b64_tr_b16 a[154:155], v69 offset:6144
    ds_read_b64_tr_b16 a[156:157], v70 offset:4096
    ds_read_b64_tr_b16 a[158:159], v70 offset:6144
    ds_read_b64_tr_b16 a[160:161], v71 offset:4096
    ds_read_b64_tr_b16 a[162:163], v71 offset:6144
    ds_read_b128 a[184:187], v66 offset:128
    ds_read_b64_tr_b16 a[168:169], v68 offset:8192
    ds_read_b64_tr_b16 a[170:171], v68 offset:10240
    ds_read_b64_tr_b16 a[172:173], v69 offset:8192
    ds_read_b64_tr_b16 a[174:175], v69 offset:10240
    ds_read_b64_tr_b16 a[176:177], v70 offset:8192
    ds_read_b64_tr_b16 a[178:179], v70 offset:10240
    ds_read_b64_tr_b16 a[180:181], v71 offset:8192
    ds_read_b64_tr_b16 a[182:183], v71 offset:10240
    s_add_u32 s52, s64, 8192
    buffer_load_dwordx4 a[224:227], v2, s[40:43], s52 offen offset:0 sc1
    buffer_load_dwordx4 a[228:231], v2, s[40:43], s52 offen offset:1024 sc1
    buffer_load_dwordx4 a[232:235], v2, s[40:43], s52 offen offset:2048 sc1
    buffer_load_dwordx4 a[236:239], v2, s[40:43], s52 offen offset:3072 sc1
    s_add_u32 s52, s64, 12288
    buffer_load_dwordx4 a[240:243], v2, s[40:43], s52 offen offset:0 sc1
    buffer_load_dwordx4 a[244:247], v2, s[40:43], s52 offen offset:1024 sc1
    buffer_load_dwordx4 a[248:251], v2, s[40:43], s52 offen offset:2048 sc1
    buffer_load_dwordx4 a[252:255], v2, s[40:43], s52 offen offset:3072 sc1
    s_waitcnt vmcnt(15)
    v_mfma_f32_16x16x32_bf16 v[204:207], a[144:147], a[192:195], 0
    v_mfma_f32_16x16x32_bf16 v[28:31], a[128:131], a[192:195], v[28:31]
    v_mfma_f32_16x16x32_bf16 v[32:35], a[132:135], a[192:195], v[32:35]
    v_mfma_f32_16x16x32_bf16 v[36:39], a[136:139], a[192:195], v[36:39]
    v_mfma_f32_16x16x32_bf16 v[40:43], a[140:143], a[192:195], v[40:43]
    s_barrier
    s_cmp_lg_u32 s50, 0
    s_cbranch_scc1 Lpub_19
    s_mov_b64 exec, 0xffff
    v_mov_b32 v8, s51
    v_lshlrev_b32 v9, 2, v1
    s_add_u32 s95, s92, 18120704
    buffer_store_dword v8, v9, s[40:43], s95 offen sc1
    s_mov_b64 exec, -1
Lpub_19:
    s_waitcnt lgkmcnt(9)
    s_waitcnt vmcnt(14)
    v_mfma_f32_16x16x32_bf16 v[204:207], a[164:167], a[196:199], v[204:207]
    ds_read_b128 a[144:147], v66 offset:192
    ds_read_b64_tr_b16 a[128:129], v68 offset:12288
    v_mfma_f32_16x16x32_bf16 v[28:31], a[148:151], a[196:199], v[28:31]
    ds_read_b64_tr_b16 a[130:131], v68 offset:14336
    ds_read_b64_tr_b16 a[132:133], v69 offset:12288
    v_mfma_f32_16x16x32_bf16 v[32:35], a[152:155], a[196:199], v[32:35]
    ds_read_b64_tr_b16 a[134:135], v69 offset:14336
    ds_read_b64_tr_b16 a[136:137], v70 offset:12288
    v_mfma_f32_16x16x32_bf16 v[36:39], a[156:159], a[196:199], v[36:39]
    ds_read_b64_tr_b16 a[138:139], v70 offset:14336
    ds_read_b64_tr_b16 a[140:141], v71 offset:12288
    v_mfma_f32_16x16x32_bf16 v[40:43], a[160:163], a[196:199], v[40:43]
    ds_read_b64_tr_b16 a[142:143], v71 offset:14336
    s_waitcnt lgkmcnt(9)
    s_waitcnt vmcnt(13)
    v_mfma_f32_16x16x32_bf16 v[204:207], a[184:187], a[200:203], v[204:207]
    ds_read_b128 a[164:167], v66 offset:256
    ds_read_b64_tr_b16 a[148:149], v68 offset:16384
    v_mfma_f32_16x16x32_bf16 v[28:31], a[168:171], a[200:203], v[28:31]
    ds_read_b64_tr_b16 a[150:151], v68 offset:18432
    ds_read_b64_tr_b16 a[152:153], v69 offset:16384
    v_mfma_f32_16x16x32_bf16 v[32:35], a[172:175], a[200:203], v[32:35]
    ds_read_b64_tr_b16 a[154:155], v69 offset:18432
    ds_read_b64_tr_b16 a[156:157], v70 offset:16384
    v_mfma_f32_16x16x32_bf16 v[36:39], a[176:179], a[200:203], v[36:39]
    ds_read_b64_tr_b16 a[158:159], v70 offset:18432
    ds_read_b64_tr_b16 a[160:161], v71 offset:16384
    v_mfma_f32_16x16x32_bf16 v[40:43], a[180:183], a[200:203], v[40:43]
    ds_read_b64_tr_b16 a[162:163], v71 offset:18432
    s_waitcnt lgkmcnt(9)
    s_waitcnt vmcnt(12)
    v_mfma_f32_16x16x32_bf16 v[204:207], a[144:147], a[204:207], v[204:207]
    ds_read_b128 a[184:187], v66 offset:320
    ds_read_b64_tr_b16 a[168:169], v68 offset:20480
    v_mfma_f32_16x16x32_bf16 v[28:31], a[128:131], a[204:207], v[28:31]
    ds_read_b64_tr_b16 a[170:171], v68 offset:22528
    ds_read_b64_tr_b16 a[172:173], v69 offset:20480
    v_mfma_f32_16x16x32_bf16 v[32:35], a[132:135], a[204:207], v[32:35]
    ds_read_b64_tr_b16 a[174:175], v69 offset:22528
    ds_read_b64_tr_b16 a[176:177], v70 offset:20480
    v_mfma_f32_16x16x32_bf16 v[36:39], a[136:139], a[204:207], v[36:39]
    ds_read_b64_tr_b16 a[178:179], v70 offset:22528
    ds_read_b64_tr_b16 a[180:181], v71 offset:20480
    v_mfma_f32_16x16x32_bf16 v[40:43], a[140:143], a[204:207], v[40:43]
    ds_read_b64_tr_b16 a[182:183], v71 offset:22528
    s_waitcnt lgkmcnt(9)
    s_waitcnt vmcnt(11)
    v_mfma_f32_16x16x32_bf16 v[204:207], a[164:167], a[208:211], v[204:207]
    ds_read_b128 a[144:147], v66 offset:384
    ds_read_b64_tr_b16 a[128:129], v68 offset:24576
    v_mfma_f32_16x16x32_bf16 v[28:31], a[148:151], a[208:211], v[28:31]
    ds_read_b64_tr_b16 a[130:131], v68 offset:26624
    ds_read_b64_tr_b16 a[132:133], v69 offset:24576
    v_mfma_f32_16x16x32_bf16 v[32:35], a[152:155], a[208:211], v[32:35]
    ds_read_b64_tr_b16 a[134:135], v69 offset:26624
    ds_read_b64_tr_b16 a[136:137], v70 offset:24576
    v_mfma_f32_16x16x32_bf16 v[36:39], a[156:159], a[208:211], v[36:39]
    ds_read_b64_tr_b16 a[138:139], v70 offset:26624
    ds_read_b64_tr_b16 a[140:141], v71 offset:24576
    v_mfma_f32_16x16x32_bf16 v[40:43], a[160:163], a[208:211], v[40:43]
    ds_read_b64_tr_b16 a[142:143], v71 offset:26624
    s_waitcnt lgkmcnt(9)
    s_waitcnt vmcnt(10)
    v_mfma_f32_16x16x32_bf16 v[204:207], a[184:187], a[212:215], v[204:207]
    ds_read_b128 a[164:167], v66 offset:448
    ds_read_b64_tr_b16 a[148:149], v68 offset:28672
    v_mfma_f32_16x16x32_bf16 v[28:31], a[168:171], a[212:215], v[28:31]
    ds_read_b64_tr_b16 a[150:151], v68 offset:30720
    ds_read_b64_tr_b16 a[152:153], v69 offset:28672
    v_mfma_f32_16x16x32_bf16 v[32:35], a[172:175], a[212:215], v[32:35]
    ds_read_b64_tr_b16 a[154:155], v69 offset:30720
    ds_read_b64_tr_b16 a[156:157], v70 offset:28672
    v_mfma_f32_16x16x32_bf16 v[36:39], a[176:179], a[212:215], v[36:39]
    ds_read_b64_tr_b16 a[158:159], v70 offset:30720
    ds_read_b64_tr_b16 a[160:161], v71 offset:28672
    v_mfma_f32_16x16x32_bf16 v[40:43], a[180:183], a[212:215], v[40:43]
    ds_read_b64_tr_b16 a[162:163], v71 offset:30720
    s_waitcnt lgkmcnt(9)
    s_waitcnt vmcnt(9)
    v_mfma_f32_16x16x32_bf16 v[204:207], a[144:147], a[216:219], v[204:207]
    ds_read_b128 a[184:187], v66 offset:512
    ds_read_b64_tr_b16 a[168:169], v68 offset:32768
    v_mfma_f32_16x16x32_bf16 v[28:31], a[128:131], a[216:219], v[28:31]
    ds_read_b64_tr_b16 a[170:171], v68 offset:34816
    ds_read_b64_tr_b16 a[172:173], v69 offset:32768
    v_mfma_f32_16x16x32_bf16 v[32:35], a[132:135], a[216:219], v[32:35]
    ds_read_b64_tr_b16 a[174:175], v69 offset:34816
    ds_read_b64_tr_b16 a[176:177], v70 offset:32768
    v_mfma_f32_16x16x32_bf16 v[36:39], a[136:139], a[216:219], v[36:39]
    ds_read_b64_tr_b16 a[178:179], v70 offset:34816
    ds_read_b64_tr_b16 a[180:181], v71 offset:32768
    v_mfma_f32_16x16x32_bf16 v[40:43], a[140:143], a[216:219], v[40:43]
    ds_read_b64_tr_b16 a[182:183], v71 offset:34816
    buffer_load_dwordx4 a[28:31], v2, s[40:43], s3 offen offset:3072 sc1
    s_waitcnt lgkmcnt(9)
    s_waitcnt vmcnt(9)
    v_mfma_f32_16x16x32_bf16 v[204:207], a[164:167], a[220:223], v[204:207]
    ds_read_b128 a[144:147], v66 offset:576
    ds_read_b64_tr_b16 a[128:129], v68 offset:36864
    v_mfma_f32_16x16x32_bf16 v[28:31], a[148:151], a[220:223], v[28:31]
    ds_read_b64_tr_b16 a[130:131], v68 offset:38912
    ds_read_b64_tr_b16 a[132:133], v69 offset:36864
    v_mfma_f32_16x16x32_bf16 v[32:35], a[152:155], a[220:223], v[32:35]
    ds_read_b64_tr_b16 a[134:135], v69 offset:38912
    ds_read_b64_tr_b16 a[136:137], v70 offset:36864
    v_mfma_f32_16x16x32_bf16 v[36:39], a[156:159], a[220:223], v[36:39]
    ds_read_b64_tr_b16 a[138:139], v70 offset:38912
    ds_read_b64_tr_b16 a[140:141], v71 offset:36864
    v_mfma_f32_16x16x32_bf16 v[40:43], a[160:163], a[220:223], v[40:43]
    ds_read_b64_tr_b16 a[142:143], v71 offset:38912
    s_add_u32 s3, s69, 8192
    buffer_load_dwordx4 a[32:35], v2, s[40:43], s3 offen offset:0 sc1
    s_waitcnt lgkmcnt(9)
    s_waitcnt vmcnt(9)
    v_mfma_f32_16x16x32_bf16 v[204:207], a[184:187], a[224:227], v[204:207]
    ds_read_b128 a[164:167], v66 offset:640
    ds_read_b64_tr_b16 a[148:149], v68 offset:40960
    v_mfma_f32_16x16x32_bf16 v[28:31], a[168:171], a[224:227], v[28:31]
    ds_read_b64_tr_b16 a[150:151], v68 offset:43008
    ds_read_b64_tr_b16 a[152:153], v69 offset:40960
    v_mfma_f32_16x16x32_bf16 v[32:35], a[172:175], a[224:227], v[32:35]
    ds_read_b64_tr_b16 a[154:155], v69 offset:43008
    ds_read_b64_tr_b16 a[156:157], v70 offset:40960
    v_mfma_f32_16x16x32_bf16 v[36:39], a[176:179], a[224:227], v[36:39]
    ds_read_b64_tr_b16 a[158:159], v70 offset:43008
    ds_read_b64_tr_b16 a[160:161], v71 offset:40960
    v_mfma_f32_16x16x32_bf16 v[40:43], a[180:183], a[224:227], v[40:43]
    ds_read_b64_tr_b16 a[162:163], v71 offset:43008
    buffer_load_dwordx4 a[36:39], v2, s[40:43], s3 offen offset:1024 sc1
    s_waitcnt lgkmcnt(9)
    s_waitcnt vmcnt(9)
    v_mfma_f32_16x16x32_bf16 v[204:207], a[144:147], a[228:231], v[204:207]
    ds_read_b128 a[184:187], v66 offset:704
    ds_read_b64_tr_b16 a[168:169], v68 offset:45056
    v_mfma_f32_16x16x32_bf16 v[28:31], a[128:131], a[228:231], v[28:31]
    ds_read_b64_tr_b16 a[170:171], v68 offset:47104
    ds_read_b64_tr_b16 a[172:173], v69 offset:45056
    v_mfma_f32_16x16x32_bf16 v[32:35], a[132:135], a[228:231], v[32:35]
    ds_read_b64_tr_b16 a[174:175], v69 offset:47104
    ds_read_b64_tr_b16 a[176:177], v70 offset:45056
    v_mfma_f32_16x16x32_bf16 v[36:39], a[136:139], a[228:231], v[36:39]
    ds_read_b64_tr_b16 a[178:179], v70 offset:47104
    ds_read_b64_tr_b16 a[180:181], v71 offset:45056
    v_mfma_f32_16x16x32_bf16 v[40:43], a[140:143], a[228:231], v[40:43]
    ds_read_b64_tr_b16 a[182:183], v71 offset:47104
    buffer_load_dwordx4 a[40:43], v2, s[40:43], s3 offen offset:2048 sc1
    s_waitcnt lgkmcnt(9)
    s_waitcnt vmcnt(9)
    v_mfma_f32_16x16x32_bf16 v[204:207], a[164:167], a[232:235], v[204:207]
    ds_read_b128 a[144:147], v66 offset:768
    ds_read_b64_tr_b16 a[128:129], v68 offset:49152
    v_mfma_f32_16x16x32_bf16 v[28:31], a[148:151], a[232:235], v[28:31]
    ds_read_b64_tr_b16 a[130:131], v68 offset:51200
    ds_read_b64_tr_b16 a[132:133], v69 offset:49152
    v_mfma_f32_16x16x32_bf16 v[32:35], a[152:155], a[232:235], v[32:35]
    ds_read_b64_tr_b16 a[134:135], v69 offset:51200
    ds_read_b64_tr_b16 a[136:137], v70 offset:49152
    v_mfma_f32_16x16x32_bf16 v[36:39], a[156:159], a[232:235], v[36:39]
    ds_read_b64_tr_b16 a[138:139], v70 offset:51200
    ds_read_b64_tr_b16 a[140:141], v71 offset:49152
    v_mfma_f32_16x16x32_bf16 v[40:43], a[160:163], a[232:235], v[40:43]
    ds_read_b64_tr_b16 a[142:143], v71 offset:51200
    buffer_load_dwordx4 a[44:47], v2, s[40:43], s3 offen offset:3072 sc1
    s_waitcnt lgkmcnt(9)
    s_waitcnt vmcnt(9)
    v_mfma_f32_16x16x32_bf16 v[204:207], a[184:187], a[236:239], v[204:207]
    ds_read_b128 a[164:167], v66 offset:832
    ds_read_b64_tr_b16 a[148:149], v68 offset:53248
    v_mfma_f32_16x16x32_bf16 v[28:31], a[168:171], a[236:239], v[28:31]
    ds_read_b64_tr_b16 a[150:151], v68 offset:55296
    ds_read_b64_tr_b16 a[152:153], v69 offset:53248
    v_mfma_f32_16x16x32_bf16 v[32:35], a[172:175], a[236:239], v[32:35]
    ds_read_b64_tr_b16 a[154:155], v69 offset:55296
    ds_read_b64_tr_b16 a[156:157], v70 offset:53248
    v_mfma_f32_16x16x32_bf16 v[36:39], a[176:179], a[236:239], v[36:39]
    ds_read_b64_tr_b16 a[158:159], v70 offset:55296
    ds_read_b64_tr_b16 a[160:161], v71 offset:53248
    v_mfma_f32_16x16x32_bf16 v[40:43], a[180:183], a[236:239], v[40:43]
    ds_read_b64_tr_b16 a[162:163], v71 offset:55296
    s_add_u32 s3, s69, 12288
    buffer_load_dwordx4 a[48:51], v2, s[40:43], s3 offen offset:0 sc1
    s_waitcnt lgkmcnt(9)
    s_waitcnt vmcnt(9)
    v_mfma_f32_16x16x32_bf16 v[204:207], a[144:147], a[240:243], v[204:207]
    ds_read_b128 a[184:187], v66 offset:896
    ds_read_b64_tr_b16 a[168:169], v68 offset:57344
    v_mfma_f32_16x16x32_bf16 v[28:31], a[128:131], a[240:243], v[28:31]
    ds_read_b64_tr_b16 a[170:171], v68 offset:59392
    ds_read_b64_tr_b16 a[172:173], v69 offset:57344
    v_mfma_f32_16x16x32_bf16 v[32:35], a[132:135], a[240:243], v[32:35]
    ds_read_b64_tr_b16 a[174:175], v69 offset:59392
    ds_read_b64_tr_b16 a[176:177], v70 offset:57344
    v_mfma_f32_16x16x32_bf16 v[36:39], a[136:139], a[240:243], v[36:39]
    ds_read_b64_tr_b16 a[178:179], v70 offset:59392
    ds_read_b64_tr_b16 a[180:181], v71 offset:57344
    v_mfma_f32_16x16x32_bf16 v[40:43], a[140:143], a[240:243], v[40:43]
    ds_read_b64_tr_b16 a[182:183], v71 offset:59392
    buffer_load_dwordx4 a[52:55], v2, s[40:43], s3 offen offset:1024 sc1
    s_waitcnt lgkmcnt(9)
    s_waitcnt vmcnt(9)
    v_mfma_f32_16x16x32_bf16 v[204:207], a[164:167], a[244:247], v[204:207]
    ds_read_b128 a[144:147], v66 offset:960
    ds_read_b64_tr_b16 a[128:129], v68 offset:61440
    v_mfma_f32_16x16x32_bf16 v[28:31], a[148:151], a[244:247], v[28:31]
    ds_read_b64_tr_b16 a[130:131], v68 offset:63488
    ds_read_b64_tr_b16 a[132:133], v69 offset:61440
    v_mfma_f32_16x16x32_bf16 v[32:35], a[152:155], a[244:247], v[32:35]
    ds_read_b64_tr_b16 a[134:135], v69 offset:63488
    ds_read_b64_tr_b16 a[136:137], v70 offset:61440
    v_mfma_f32_16x16x32_bf16 v[36:39], a[156:159], a[244:247], v[36:39]
    ds_read_b64_tr_b16 a[138:139], v70 offset:63488
    ds_read_b64_tr_b16 a[140:141], v71 offset:61440
    v_mfma_f32_16x16x32_bf16 v[40:43], a[160:163], a[244:247], v[40:43]
    ds_read_b64_tr_b16 a[142:143], v71 offset:63488
    buffer_load_dwordx4 a[56:59], v2, s[40:43], s3 offen offset:2048 sc1
    s_waitcnt lgkmcnt(9)
    s_waitcnt vmcnt(9)
    v_mfma_f32_16x16x32_bf16 v[204:207], a[184:187], a[248:251], v[204:207]
    v_mfma_f32_16x16x32_bf16 v[28:31], a[168:171], a[248:251], v[28:31]
    v_mfma_f32_16x16x32_bf16 v[32:35], a[172:175], a[248:251], v[32:35]
    v_mfma_f32_16x16x32_bf16 v[36:39], a[176:179], a[248:251], v[36:39]
    v_mfma_f32_16x16x32_bf16 v[40:43], a[180:183], a[248:251], v[40:43]
    buffer_load_dwordx4 a[60:63], v2, s[40:43], s3 offen offset:3072 sc1
    s_waitcnt lgkmcnt(0)
    s_waitcnt vmcnt(9)
    v_mfma_f32_16x16x32_bf16 v[204:207], a[144:147], a[252:255], v[204:207]
    v_mfma_f32_16x16x32_bf16 v[28:31], a[128:131], a[252:255], v[28:31]
    v_mfma_f32_16x16x32_bf16 v[32:35], a[132:135], a[252:255], v[32:35]
    v_mfma_f32_16x16x32_bf16 v[36:39], a[136:139], a[252:255], v[36:39]
    v_mfma_f32_16x16x32_bf16 v[40:43], a[140:143], a[252:255], v[40:43]
    s_add_u32 s3, s69, 16384
    buffer_load_dwordx4 a[64:67], v2, s[40:43], s3 offen offset:0 sc1
    s_nop 1
    v_add_f32 v204, v204, v205
    s_add_u32 s52, s76, 2097152
    v_pk_add_f32 v[172:173], v[28:29], v[204:205] op_sel_hi:[1,0] neg_lo:[0,1] neg_hi:[0,1]
    v_pk_add_f32 v[174:175], v[30:31], v[204:205] op_sel_hi:[1,0] neg_lo:[0,1] neg_hi:[0,1]
    v_pk_add_f32 v[176:177], v[32:33], v[204:205] op_sel_hi:[1,0] neg_lo:[0,1] neg_hi:[0,1]
    v_pk_add_f32 v[178:179], v[34:35], v[204:205] op_sel_hi:[1,0] neg_lo:[0,1] neg_hi:[0,1]
    v_pk_add_f32 v[180:181], v[36:37], v[204:205] op_sel_hi:[1,0] neg_lo:[0,1] neg_hi:[0,1]
    v_pk_add_f32 v[182:183], v[38:39], v[204:205] op_sel_hi:[1,0] neg_lo:[0,1] neg_hi:[0,1]
    v_pk_add_f32 v[184:185], v[40:41], v[204:205] op_sel_hi:[1,0] neg_lo:[0,1] neg_hi:[0,1]
    v_pk_add_f32 v[186:187], v[42:43], v[204:205] op_sel_hi:[1,0] neg_lo:[0,1] neg_hi:[0,1]
    v_cvt_pk_bf16_f32 v156, v172, v173
    v_cvt_pk_bf16_f32 v157, v174, v175
    v_cvt_pk_bf16_f32 v158, v176, v177
    v_cvt_pk_bf16_f32 v159, v178, v179
    v_cvt_pk_bf16_f32 v160, v180, v181
    v_cvt_pk_bf16_f32 v161, v182, v183
    v_cvt_pk_bf16_f32 v162, v184, v185
    v_cvt_pk_bf16_f32 v163, v186, v187
    buffer_store_dwordx4 v[156:159], v2, s[40:43], s52 offen offset:0 sc1
    buffer_store_dwordx4 v[160:163], v2, s[40:43], s52 offen offset:1024 sc1
    v_pk_mul_f32 v[164:165], v[172:173], v[172:173]
    v_pk_mul_f32 v[166:167], v[174:175], v[174:175]
    v_pk_fma_f32 v[164:165], v[176:177], v[176:177], v[164:165]
    v_pk_fma_f32 v[166:167], v[178:179], v[178:179], v[166:167]
    v_pk_fma_f32 v[164:165], v[180:181], v[180:181], v[164:165]
    v_pk_fma_f32 v[166:167], v[182:183], v[182:183], v[166:167]
    v_pk_fma_f32 v[164:165], v[184:185], v[184:185], v[164:165]
    v_pk_fma_f32 v[166:167], v[186:187], v[186:187], v[166:167]
    v_pk_add_f32 v[164:165], v[164:165], v[166:167]
    v_add_f32 v164, v164, v165
    v_mov_b32 v12, v164
    s_nop 1
    v_permlane16_swap_b32 v164, v12
    v_add_f32 v164, v164, v12
    v_mov_b32 v12, v164
    s_nop 1
    v_permlane32_swap_b32 v164, v12
    v_add_f32 v164, v164, v12
    v_lshlrev_b32 v12, 2, v10
    s_mov_b64 exec, 0xffff
    buffer_store_dword v164, v12, s[40:43], s81 offen sc1
    s_mov_b64 exec, -1
    buffer_load_dwordx4 a[68:71], v2, s[40:43], s3 offen offset:1024 sc1
    v_lshlrev_b32 v145, 6, v10
    v_lshl_add_u32 v145, v3, 4, v145
    v_lshlrev_b32 v14, 2, v3
    v_cvt_f32_u32 v14, v14
    s_lshl_b32 s52, s50, 4
    v_add_u32 v12, s52, v10
    v_cvt_f32_u32 v12, v12
    v_mul_f32 v12, 0x3c800000, v12
    v_mul_f32 v13, v14, v12
    v_fmamk_f32 v16, v12, 0x00000000, v13
    v_fmamk_f32 v17, v12, 0x3f800000, v13
    v_cos_f32 v18, v16
    v_cos_f32 v19, v17
    v_sin_f32 v16, v16
    buffer_load_dwordx4 a[72:75], v2, s[40:43], s3 offen offset:2048 sc1
    v_sin_f32 v17, v17
    v_cvt_pk_bf16_f32 v148, v18, v19
    v_cvt_pk_bf16_f32 v156, v16, v17
    v_xor_b32 v164, 0x80008000, v156
    v_fmamk_f32 v16, v12, 0x40000000, v13
    v_fmamk_f32 v17, v12, 0x40400000, v13
    v_cos_f32 v18, v16
    v_cos_f32 v19, v17
    v_sin_f32 v16, v16
    v_sin_f32 v17, v17
    v_cvt_pk_bf16_f32 v149, v18, v19
    v_cvt_pk_bf16_f32 v157, v16, v17
    v_xor_b32 v165, 0x80008000, v157
    buffer_load_dwordx4 a[76:79], v2, s[40:43], s3 offen offset:3072 sc1
    v_fmamk_f32 v16, v12, 0x41800000, v13
    v_fmamk_f32 v17, v12, 0x41880000, v13
    v_cos_f32 v18, v16
    v_cos_f32 v19, v17
    v_sin_f32 v16, v16
    v_sin_f32 v17, v17
    v_cvt_pk_bf16_f32 v150, v18, v19
    v_cvt_pk_bf16_f32 v158, v16, v17
    v_xor_b32 v166, 0x80008000, v158
    v_fmamk_f32 v16, v12, 0x41900000, v13
    v_fmamk_f32 v17, v12, 0x41980000, v13
    v_cos_f32 v18, v16
    s_add_u32 s3, s69, 20480
    buffer_load_dwordx4 a[80:83], v2, s[40:43], s3 offen offset:0 sc1
    v_cos_f32 v19, v17
    v_sin_f32 v16, v16
    v_sin_f32 v17, v17
    v_cvt_pk_bf16_f32 v151, v18, v19
    v_cvt_pk_bf16_f32 v159, v16, v17
    v_xor_b32 v167, 0x80008000, v159
    v_fmamk_f32 v16, v12, 0x42000000, v13
    v_fmamk_f32 v17, v12, 0x42040000, v13
    v_cos_f32 v18, v16
    v_cos_f32 v19, v17
    v_sin_f32 v16, v16
    buffer_load_dwordx4 a[84:87], v2, s[40:43], s3 offen offset:1024 sc1
    v_sin_f32 v17, v17
    v_cvt_pk_bf16_f32 v152, v18, v19
    v_cvt_pk_bf16_f32 v160, v16, v17
    v_xor_b32 v168, 0x80008000, v160
    v_fmamk_f32 v16, v12, 0x42080000, v13
    v_fmamk_f32 v17, v12, 0x420c0000, v13
    v_cos_f32 v18, v16
    v_cos_f32 v19, v17
    v_sin_f32 v16, v16
    v_sin_f32 v17, v17
    v_cvt_pk_bf16_f32 v153, v18, v19
    v_cvt_pk_bf16_f32 v161, v16, v17
    v_xor_b32 v169, 0x80008000, v161
    buffer_load_dwordx4 a[88:91], v2, s[40:43], s3 offen offset:2048 sc1
    v_fmamk_f32 v16, v12, 0x42400000, v13
    v_fmamk_f32 v17, v12, 0x42440000, v13
    v_cos_f32 v18, v16
    v_cos_f32 v19, v17
    v_sin_f32 v16, v16
    v_sin_f32 v17, v17
    v_cvt_pk_bf16_f32 v154, v18, v19
    v_cvt_pk_bf16_f32 v162, v16, v17
    v_xor_b32 v170, 0x80008000, v162
    v_fmamk_f32 v16, v12, 0x42480000, v13
    v_fmamk_f32 v17, v12, 0x424c0000, v13
    v_cos_f32 v18, v16
    buffer_load_dwordx4 a[92:95], v2, s[40:43], s3 offen offset:3072 sc1
    v_cos_f32 v19, v17
    v_sin_f32 v16, v16
    v_sin_f32 v17, v17
    v_cvt_pk_bf16_f32 v155, v18, v19
    v_cvt_pk_bf16_f32 v163, v16, v17
    v_xor_b32 v171, 0x80008000, v163
    v_lshlrev_b32 v14, 2, v3
    v_cvt_f32_u32 v14, v14
    s_lshl_b32 s52, s50, 4
    v_add_u32 v12, s52, v10
    v_cvt_f32_u32 v12, v12
    v_mul_f32 v12, 0x3a000000, v12
    v_mul_f32 v13, v14, v12
    v_fmamk_f32 v16, v12, 0x00000000, v13
    s_add_u32 s3, s69, 24576
    buffer_load_dwordx4 a[96:99], v2, s[40:43], s3 offen offset:0 sc1
    v_cos_f32 v196, v16
    v_sin_f32 v204, v16
    v_fmamk_f32 v17, v12, 0x3f800000, v13
    v_cos_f32 v197, v17
    v_sin_f32 v205, v17
    v_fmamk_f32 v16, v12, 0x40000000, v13
    v_cos_f32 v198, v16
    v_sin_f32 v206, v16
    v_fmamk_f32 v17, v12, 0x40400000, v13
    v_cos_f32 v199, v17
    s_load_dword s12, s[22:23], 32768 glc
    s_load_dword s13, s[22:23], 33792 glc
    s_load_dword s14, s[22:23], 34816 glc
    s_load_dword s15, s[22:23], 35840 glc
    s_load_dword s16, s[22:23], 36864 glc
    s_load_dword s17, s[22:23], 37888 glc
    s_load_dword s18, s[22:23], 38912 glc
    s_load_dword s19, s[22:23], 39936 glc
    buffer_load_dwordx4 a[100:103], v2, s[40:43], s3 offen offset:1024 sc1
    v_sin_f32 v207, v17
    v_fmamk_f32 v16, v12, 0x41800000, v13
    v_cos_f32 v200, v16
    v_sin_f32 v208, v16
    v_fmamk_f32 v17, v12, 0x41880000, v13
    v_cos_f32 v201, v17
    v_sin_f32 v209, v17
    v_fmamk_f32 v16, v12, 0x41900000, v13
    v_cos_f32 v202, v16
    v_sin_f32 v210, v16
    v_fmamk_f32 v17, v12, 0x41980000, v13
    s_waitcnt vmcnt(9)
    s_barrier
    s_cmp_lg_u32 s50, 0
    s_cbranch_scc1 Lpub_21
    s_mov_b64 exec, 0xffff
    v_mov_b32 v8, s51
    v_lshlrev_b32 v9, 2, v1
    s_add_u32 s95, s92, 18153472
    buffer_store_dword v8, v9, s[40:43], s95 offen sc1
    s_mov_b64 exec, -1
Lpub_21:
    buffer_load_dwordx4 a[104:107], v2, s[40:43], s3 offen offset:2048 sc1
    v_cos_f32 v203, v17
    v_sin_f32 v211, v17
    v_mul_f32 v196, s82, v196
    v_mul_f32 v204, s82, v204
    v_mul_f32 v197, s82, v197
    v_mul_f32 v205, s82, v205
    v_mul_f32 v198, s82, v198
    v_mul_f32 v206, s82, v206
    v_mul_f32 v199, s82, v199
    v_mul_f32 v207, s82, v207
    v_mul_f32 v200, s82, v200
    v_mul_f32 v208, s82, v208
    v_mul_f32 v201, s82, v201
    v_mul_f32 v209, s82, v209
    v_mul_f32 v202, s82, v202
    v_mul_f32 v210, s82, v210
    buffer_load_dwordx4 a[108:111], v2, s[40:43], s3 offen offset:3072 sc1
    v_mul_f32 v203, s82, v203
    v_mul_f32 v211, s82, v211
    v_add_u32 v12, 0, v10
    v_cvt_f32_u32 v12, v12
    v_mul_f32 v12, 0x3d000000, v12
    v_mul_f32 v13, v14, v12
    v_fmamk_f32 v16, v12, 0x00000000, v13
    v_fmamk_f32 v17, v12, 0x3f800000, v13
    v_cos_f32 v18, v16
    v_cos_f32 v19, v17
    v_sin_f32 v16, v16
    v_sin_f32 v17, v17
    v_cvt_pk_bf16_f32 v172, v18, v19
    v_cvt_pk_bf16_f32 v180, v16, v17
    s_add_u32 s3, s69, 28672
    buffer_load_dwordx4 a[112:115], v2, s[40:43], s3 offen offset:0 sc1
    v_xor_b32 v188, 0x80008000, v180
    v_fmamk_f32 v16, v12, 0x40000000, v13
    v_fmamk_f32 v17, v12, 0x40400000, v13
    v_cos_f32 v18, v16
    v_cos_f32 v19, v17
    v_sin_f32 v16, v16
    v_sin_f32 v17, v17
    v_cvt_pk_bf16_f32 v173, v18, v19
    v_cvt_pk_bf16_f32 v181, v16, v17
    v_xor_b32 v189, 0x80008000, v181
    v_fmamk_f32 v16, v12, 0x41800000, v13
    v_fmamk_f32 v17, v12, 0x41880000, v13
    v_cos_f32 v18, v16
    buffer_load_dwordx4 a[116:119], v2, s[40:43], s3 offen offset:1024 sc1
    v_cos_f32 v19, v17
    v_sin_f32 v16, v16
    v_sin_f32 v17, v17
    v_cvt_pk_bf16_f32 v174, v18, v19
    v_cvt_pk_bf16_f32 v182, v16, v17
    v_xor_b32 v190, 0x80008000, v182
    v_fmamk_f32 v16, v12, 0x41900000, v13
    v_fmamk_f32 v17, v12, 0x41980000, v13
    v_cos_f32 v18, v16
    v_cos_f32 v19, v17
    v_sin_f32 v16, v16
    buffer_load_dwordx4 a[120:123], v2, s[40:43], s3 offen offset:2048 sc1
    v_sin_f32 v17, v17
    v_cvt_pk_bf16_f32 v175, v18, v19
    v_cvt_pk_bf16_f32 v183, v16, v17
    v_xor_b32 v191, 0x80008000, v183
    v_add_u32 v12, 16, v10
    v_cvt_f32_u32 v12, v12
    v_mul_f32 v12, 0x3d000000, v12
    v_mul_f32 v13, v14, v12
    v_fmamk_f32 v16, v12, 0x00000000, v13
    v_fmamk_f32 v17, v12, 0x3f800000, v13
    v_cos_f32 v18, v16
    v_cos_f32 v19, v17
    v_sin_f32 v16, v16
    buffer_load_dwordx4 a[124:127], v2, s[40:43], s3 offen offset:3072 sc1
    v_sin_f32 v17, v17
    v_cvt_pk_bf16_f32 v176, v18, v19
    v_cvt_pk_bf16_f32 v184, v16, v17
    v_xor_b32 v192, 0x80008000, v184
    v_fmamk_f32 v16, v12, 0x40000000, v13
    v_fmamk_f32 v17, v12, 0x40400000, v13
    v_cos_f32 v18, v16
    v_cos_f32 v19, v17
    v_sin_f32 v16, v16
    v_sin_f32 v17, v17
    v_cvt_pk_bf16_f32 v177, v18, v19
    v_cvt_pk_bf16_f32 v185, v16, v17
    v_xor_b32 v193, 0x80008000, v185
    s_add_u32 s3, s70, 0
    buffer_load_dwordx4 a[128:131], v2, s[40:43], s3 offen offset:0 sc1
    v_fmamk_f32 v16, v12, 0x41800000, v13
    v_fmamk_f32 v17, v12, 0x41880000, v13
    v_cos_f32 v18, v16
    v_cos_f32 v19, v17
    v_sin_f32 v16, v16
    v_sin_f32 v17, v17
    v_cvt_pk_bf16_f32 v178, v18, v19
    v_cvt_pk_bf16_f32 v186, v16, v17
    v_xor_b32 v194, 0x80008000, v186
    v_fmamk_f32 v16, v12, 0x41900000, v13
    v_fmamk_f32 v17, v12, 0x41980000, v13
    v_cos_f32 v18, v16
    buffer_load_dwordx4 a[132:135], v2, s[40:43], s3 offen offset:1024 sc1
    v_cos_f32 v19, v17
    v_sin_f32 v16, v16
    v_sin_f32 v17, v17
    v_cvt_pk_bf16_f32 v179, v18, v19
    v_cvt_pk_bf16_f32 v187, v16, v17
    v_xor_b32 v195, 0x80008000, v187
    v_lshlrev_b32 v12, 13, v3
    v_bfe_u32 v13, v1, 3, 1
    v_lshl_add_u32 v12, v13, 10, v12
    v_and_b32 v13, 0x7f, v44
    v_add_u32 v144, v12, v13
    v_lshlrev_b32 v12, 9, v3
    v_add_u32 v12, 137216, v12
    v_add_u32 v48, v12, v52
    v_add_u32 v49, v12, v53
    buffer_load_dwordx4 a[136:139], v2, s[40:43], s3 offen offset:2048 sc1
    v_add_u32 v50, v12, v54
    v_add_u32 v51, v12, v55
    s_add_u32 s52, s66, 145408
    v_bfe_u32 v14, v1, 1, 2
    v_lshlrev_b32 v15, 7, v10
    v_lshl_add_u32 v15, v3, 3, v15
    v_add_u32 v15, s52, v15
    v_xor_b32 v16, 0, v14
    v_lshl_add_u32 v140, v16, 5, v15
    v_xor_b32 v16, 1, v14
    v_lshl_add_u32 v141, v16, 5, v15
    v_xor_b32 v16, 2, v14
    v_lshl_add_u32 v142, v16, 5, v15
    v_xor_b32 v16, 3, v14
    v_lshl_add_u32 v143, v16, 5, v15
    v_lshrrev_b32 v12, 1, v10
    v_lshlrev_b32 v12, 16, v12
    v_and_b32 v13, 1, v1
    buffer_load_dwordx4 a[140:143], v2, s[40:43], s3 offen offset:3072 sc1
    v_lshl_add_u32 v12, v13, 6, v12
    v_add_u32 v146, v12, v58
    s_mov_b32 s56, 0
    s_waitcnt lgkmcnt(0)
    s_xor_b64 s[12:13], s[12:13], s[10:11]
    s_xor_b64 s[14:15], s[14:15], s[10:11]
    s_xor_b64 s[16:17], s[16:17], s[10:11]
    s_xor_b64 s[18:19], s[18:19], s[10:11]
    s_or_b64 s[12:13], s[12:13], s[14:15]
    s_or_b64 s[12:13], s[12:13], s[16:17]
    s_or_b64 s[12:13], s[12:13], s[18:19]
    s_cbranch_scc0 Ldone_24
Lpoll_23:
    s_sleep 4
    s_load_dword s12, s[22:23], 32768 glc
    s_load_dword s13, s[22:23], 33792 glc
    s_load_dword s14, s[22:23], 34816 glc
    s_load_dword s15, s[22:23], 35840 glc
    s_load_dword s16, s[22:23], 36864 glc
    s_load_dword s17, s[22:23], 37888 glc
    s_load_dword s18, s[22:23], 38912 glc
    s_load_dword s19, s[22:23], 39936 glc
    s_add_u32 s56, s56, 1
    s_cmp_gt_u32 s56, 0x40000
    s_cbranch_scc1 Ldone_24
    s_waitcnt lgkmcnt(0)
    s_xor_b64 s[12:13], s[12:13], s[10:11]
    s_xor_b64 s[14:15], s[14:15], s[10:11]
    s_xor_b64 s[16:17], s[16:17], s[10:11]
    s_xor_b64 s[18:19], s[18:19], s[10:11]
    s_or_b64 s[12:13], s[12:13], s[14:15]
    s_or_b64 s[12:13], s[12:13], s[16:17]
    s_or_b64 s[12:13], s[12:13], s[18:19]
    s_cbranch_scc0 Ldone_24
    s_branch Lpoll_23
Ldone_24:
    s_barrier
    s_add_u32 m0, s66, 137216
    s_add_u32 s52, s84, 4194304
    buffer_load_dwordx4 v144, s[40:43], s52 offen sc1 lds
    s_add_u32 m0, s66, 138240
    s_add_u32 s52, s84, 4227072
    buffer_load_dwordx4 v144, s[40:43], s52 offen sc1 lds
    s_add_u32 s60, s83, 4096
    buffer_load_dwordx4 v[116:119], v145, s[40:43], s83 offen sc1
    buffer_load_dwordx4 v[120:123], v145, s[40:43], s60 offen sc1
    s_load_dword s12, s[20:21], 65536 glc
    s_load_dword s13, s[20:21], 65664 glc
    s_lshl_b32 s85, s48, 16
    s_lshl_b32 s53, s50, 13
    s_add_u32 s85, s85, s53
    s_add_u32 s85, s85, 2097152
    s_lshl_b32 s86, s50, 13
    s_lshl_b32 s87, s50, 19
    s_lshl_b32 s53, s49, 13
    s_add_u32 s87, s87, s53
    s_lshl_b32 s53, s48, 8
    s_add_u32 s87, s87, s53
    s_add_u32 s87, s87, 8388608
    s_lshl_b32 s88, s48, 11
    s_add_u32 s88, s88, 17825792
    s_mul_i32 s89, s49, 229376
    s_mul_i32 s53, s50, 57344
    s_add_u32 s89, s89, s53
    s_add_u32 s89, s89, 20971520
    s_mul_i32 s90, s48, 229376
    s_mul_i32 s53, s49, 28672
    s_add_u32 s90, s90, s53
    s_lshl_b32 s53, s50, 12
    s_add_u32 s90, s90, s53
    s_add_u32 s90, s90, 10485760
    s_add_u32 s3, s70, 4096
    buffer_load_dwordx4 a[144:147], v2, s[40:43], s3 offen offset:0 sc1
    buffer_load_dwordx4 a[148:151], v2, s[40:43], s3 offen offset:1024 sc1
    buffer_load_dwordx4 a[152:155], v2, s[40:43], s3 offen offset:2048 sc1
    buffer_load_dwordx4 a[156:159], v2, s[40:43], s3 offen offset:3072 sc1
    s_add_u32 s3, s70, 8192
    buffer_load_dwordx4 a[160:163], v2, s[40:43], s3 offen offset:0 sc1
    buffer_load_dwordx4 a[164:167], v2, s[40:43], s3 offen offset:1024 sc1
    buffer_load_dwordx4 a[168:171], v2, s[40:43], s3 offen offset:2048 sc1
    buffer_load_dwordx4 a[172:175], v2, s[40:43], s3 offen offset:3072 sc1
    s_add_u32 s3, s70, 12288
    buffer_load_dwordx4 a[176:179], v2, s[40:43], s3 offen offset:0 sc1
    buffer_load_dwordx4 a[180:183], v2, s[40:43], s3 offen offset:1024 sc1
    s_mov_b32 s56, 0
    s_waitcnt lgkmcnt(0)
    s_xor_b64 s[12:13], s[12:13], s[10:11]
    s_cbranch_scc0 Ldone_27
Lpoll_26:
    s_sleep 4
    s_load_dword s12, s[20:21], 65536 glc
    s_load_dword s13, s[20:21], 65664 glc
    s_add_u32 s56, s56, 1
    s_cmp_gt_u32 s56, 0x40000
    s_cbranch_scc1 Ldone_27
    s_waitcnt lgkmcnt(0)
    s_xor_b64 s[12:13], s[12:13], s[10:11]
    s_cbranch_scc0 Ldone_27
    s_branch Lpoll_26
Ldone_27:
    s_waitcnt vmcnt(12)
    s_barrier
    ds_read_b64_tr_b16 v[76:77], v48 offset:0
    ds_read_b64_tr_b16 v[78:79], v48 offset:2048
    ds_read_b64_tr_b16 v[92:93], v50 offset:0
    ds_read_b64_tr_b16 v[94:95], v50 offset:2048
    ds_read_b64_tr_b16 v[84:85], v49 offset:0
    ds_read_b64_tr_b16 v[86:87], v49 offset:2048
    ds_read_b64_tr_b16 v[100:101], v51 offset:0
    ds_read_b64_tr_b16 v[102:103], v51 offset:2048
    ds_read_b64_tr_b16 v[80:81], v48 offset:4096
    ds_read_b64_tr_b16 v[82:83], v48 offset:6144
    ds_read_b64_tr_b16 v[96:97], v50 offset:4096
    ds_read_b64_tr_b16 v[98:99], v50 offset:6144
    ds_read_b64_tr_b16 v[88:89], v49 offset:4096
    ds_read_b64_tr_b16 v[90:91], v49 offset:6144
    ds_read_b64_tr_b16 v[104:105], v51 offset:4096
    ds_read_b64_tr_b16 v[106:107], v51 offset:6144
    s_add_u32 m0, s86, 0
    s_add_u32 s59, s85, 0
    buffer_load_dwordx4 v2, s[40:43], s59 offen offset:0 sc1 lds
    s_waitcnt lgkmcnt(14)
    v_mfma_f32_16x16x32_bf16 v[124:127], v[76:79], v[148:151], 0
    s_waitcnt lgkmcnt(12)
    v_mfma_f32_16x16x32_bf16 v[132:135], v[92:95], v[148:151], 0
    s_waitcnt lgkmcnt(10)
    v_mfma_f32_16x16x32_bf16 v[128:131], v[84:87], v[148:151], 0
    s_waitcnt lgkmcnt(8)
    v_mfma_f32_16x16x32_bf16 v[136:139], v[100:103], v[148:151], 0
    buffer_load_dwordx4 v2, s[40:43], s59 offen offset:1024 sc1 lds
    v_mfma_f32_16x16x32_bf16 v[124:127], v[92:95], v[156:159], v[124:127]
    v_mfma_f32_16x16x32_bf16 v[132:135], v[76:79], v[164:167], v[132:135]
    v_mfma_f32_16x16x32_bf16 v[128:131], v[100:103], v[156:159], v[128:131]
    v_mfma_f32_16x16x32_bf16 v[136:139], v[84:87], v[164:167], v[136:139]
    buffer_load_dwordx4 v2, s[40:43], s59 offen offset:2048 sc1 lds
    s_waitcnt lgkmcnt(6)
    v_mfma_f32_16x16x32_bf16 v[124:127], v[80:83], v[152:155], v[124:127]
    s_waitcnt lgkmcnt(4)
    v_mfma_f32_16x16x32_bf16 v[132:135], v[96:99], v[152:155], v[132:135]
    s_waitcnt lgkmcnt(2)
    v_mfma_f32_16x16x32_bf16 v[128:131], v[88:91], v[152:155], v[128:131]
    s_waitcnt lgkmcnt(0)
    v_mfma_f32_16x16x32_bf16 v[136:139], v[104:107], v[152:155], v[136:139]
    buffer_load_dwordx4 v2, s[40:43], s59 offen offset:3072 sc1 lds
    v_mfma_f32_16x16x32_bf16 v[124:127], v[96:99], v[160:163], v[124:127]
    v_mfma_f32_16x16x32_bf16 v[132:135], v[80:83], v[168:171], v[132:135]
    v_mfma_f32_16x16x32_bf16 v[128:131], v[104:107], v[160:163], v[128:131]
    v_mfma_f32_16x16x32_bf16 v[136:139], v[88:91], v[168:171], v[136:139]
    s_add_u32 m0, s86, 4096
    s_add_u32 s59, s85, 4096
    buffer_load_dwordx4 v2, s[40:43], s59 offen offset:0 sc1 lds
    s_nop 1
    v_pk_mul_f32 v[76:77], v[124:125], v[196:197]
    v_pk_mul_f32 v[84:85], v[132:133], v[196:197]
    v_pk_mul_f32 v[78:79], v[126:127], v[198:199]
    v_pk_mul_f32 v[86:87], v[134:135], v[198:199]
    v_pk_mul_f32 v[80:81], v[128:129], v[200:201]
    v_pk_mul_f32 v[88:89], v[136:137], v[200:201]
    v_pk_mul_f32 v[82:83], v[130:131], v[202:203]
    v_pk_mul_f32 v[90:91], v[138:139], v[202:203]
    v_pk_fma_f32 v[76:77], v[132:133], v[204:205], v[76:77]
    v_pk_fma_f32 v[84:85], v[124:125], v[204:205], v[84:85] neg_lo:[0,1,0] neg_hi:[0,1,0]
    v_pk_fma_f32 v[78:79], v[134:135], v[206:207], v[78:79]
    v_pk_fma_f32 v[86:87], v[126:127], v[206:207], v[86:87] neg_lo:[0,1,0] neg_hi:[0,1,0]
    v_pk_fma_f32 v[80:81], v[136:137], v[208:209], v[80:81]
    v_pk_fma_f32 v[88:89], v[128:129], v[208:209], v[88:89] neg_lo:[0,1,0] neg_hi:[0,1,0]
    v_pk_fma_f32 v[82:83], v[138:139], v[210:211], v[82:83]
    v_pk_fma_f32 v[90:91], v[130:131], v[210:211], v[90:91] neg_lo:[0,1,0] neg_hi:[0,1,0]
    buffer_load_dwordx4 v2, s[40:43], s59 offen offset:1024 sc1 lds
    v_cvt_pk_bf16_f32 v108, v76, v77
    v_cvt_pk_bf16_f32 v109, v78, v79
    v_cvt_pk_bf16_f32 v110, v80, v81
    v_cvt_pk_bf16_f32 v111, v82, v83
    v_cvt_pk_bf16_f32 v112, v84, v85
    v_cvt_pk_bf16_f32 v113, v86, v87
    v_cvt_pk_bf16_f32 v114, v88, v89
    v_cvt_pk_bf16_f32 v115, v90, v91
    v_mfma_f32_16x16x32_bf16 v[124:127], v[172:175], v[108:111], 0
    s_nop 0
    v_mfma_f32_16x16x32_bf16 v[132:135], v[172:175], v[112:115], 0
    v_mfma_f32_16x16x32_bf16 v[128:131], v[176:179], v[108:111], 0
    v_mfma_f32_16x16x32_bf16 v[136:139], v[176:179], v[112:115], 0
    v_mfma_f32_16x16x32_bf16 v[124:127], v[180:183], v[112:115], v[124:127]
    v_mfma_f32_16x16x32_bf16 v[132:135], v[188:191], v[108:111], v[132:135]
    v_mfma_f32_16x16x32_bf16 v[128:131], v[184:187], v[112:115], v[128:131]
    v_mfma_f32_16x16x32_bf16 v[136:139], v[192:195], v[108:111], v[136:139]
    buffer_load_dwordx4 v2, s[40:43], s59 offen offset:2048 sc1 lds
    s_waitcnt vmcnt(18)
    v_lshlrev_b32 v92, 16, v116
    v_and_b32 v93, 0xffff0000, v116
    v_lshlrev_b32 v100, 16, v118
    v_and_b32 v101, 0xffff0000, v118
    v_lshlrev_b32 v94, 16, v117
    v_and_b32 v95, 0xffff0000, v117
    v_lshlrev_b32 v102, 16, v119
    v_and_b32 v103, 0xffff0000, v119
    s_waitcnt vmcnt(17)
    v_lshlrev_b32 v96, 16, v120
    v_and_b32 v97, 0xffff0000, v120
    v_lshlrev_b32 v104, 16, v122
    v_and_b32 v105, 0xffff0000, v122
    v_lshlrev_b32 v98, 16, v121
    v_and_b32 v99, 0xffff0000, v121
    v_lshlrev_b32 v106, 16, v123
    v_and_b32 v107, 0xffff0000, v123
    v_pk_mul_f32 v[76:77], v[124:125], v[92:93]
    v_pk_mul_f32 v[84:85], v[132:133], v[92:93]
    v_pk_mul_f32 v[78:79], v[126:127], v[94:95]
    v_pk_mul_f32 v[86:87], v[134:135], v[94:95]
    v_pk_mul_f32 v[80:81], v[128:129], v[96:97]
    v_pk_mul_f32 v[88:89], v[136:137], v[96:97]
    v_pk_mul_f32 v[82:83], v[130:131], v[98:99]
    v_pk_mul_f32 v[90:91], v[138:139], v[98:99]
    v_pk_fma_f32 v[76:77], v[132:133], v[100:101], v[76:77] neg_lo:[0,1,0] neg_hi:[0,1,0]
    v_pk_fma_f32 v[84:85], v[124:125], v[100:101], v[84:85]
    v_pk_fma_f32 v[78:79], v[134:135], v[102:103], v[78:79] neg_lo:[0,1,0] neg_hi:[0,1,0]
    v_pk_fma_f32 v[86:87], v[126:127], v[102:103], v[86:87]
    v_pk_fma_f32 v[80:81], v[136:137], v[104:105], v[80:81] neg_lo:[0,1,0] neg_hi:[0,1,0]
    v_pk_fma_f32 v[88:89], v[128:129], v[104:105], v[88:89]
    v_pk_fma_f32 v[82:83], v[138:139], v[106:107], v[82:83] neg_lo:[0,1,0] neg_hi:[0,1,0]
    v_pk_fma_f32 v[90:91], v[130:131], v[106:107], v[90:91]
    buffer_load_dwordx4 v2, s[40:43], s59 offen offset:3072 sc1 lds
    v_cvt_pk_bf16_f32 v108, v76, v77
    v_cvt_pk_bf16_f32 v109, v78, v79
    v_cvt_pk_bf16_f32 v110, v80, v81
    v_cvt_pk_bf16_f32 v111, v82, v83
    v_cvt_pk_bf16_f32 v112, v84, v85
    v_cvt_pk_bf16_f32 v113, v86, v87
    v_cvt_pk_bf16_f32 v114, v88, v89
    v_cvt_pk_bf16_f32 v115, v90, v91
    v_mfma_f32_16x16x32_bf16 v[124:127], v[172:175], v[108:111], 0
    s_nop 0
    v_mfma_f32_16x16x32_bf16 v[132:135], v[172:175], v[112:115], 0
    v_mfma_f32_16x16x32_bf16 v[128:131], v[176:179], v[108:111], 0
    v_mfma_f32_16x16x32_bf16 v[136:139], v[176:179], v[112:115], 0
    v_mfma_f32_16x16x32_bf16 v[124:127], v[188:191], v[112:115], v[124:127]
    v_mfma_f32_16x16x32_bf16 v[132:135], v[180:183], v[108:111], v[132:135]
    v_mfma_f32_16x16x32_bf16 v[128:131], v[192:195], v[112:115], v[128:131]
    v_mfma_f32_16x16x32_bf16 v[136:139], v[184:187], v[108:111], v[136:139]
    s_add_u32 m0, s86, 32768
    s_add_u32 s59, s85, 32768
    buffer_load_dwordx4 v2, s[40:43], s59 offen offset:0 sc1 lds
    s_nop 1
    v_pk_mul_f32 v[76:77], v[124:125], v[196:197]
    v_pk_mul_f32 v[84:85], v[132:133], v[196:197]
    v_pk_mul_f32 v[78:79], v[126:127], v[198:199]
    v_pk_mul_f32 v[86:87], v[134:135], v[198:199]
    v_pk_mul_f32 v[80:81], v[128:129], v[200:201]
    v_pk_mul_f32 v[88:89], v[136:137], v[200:201]
    v_pk_mul_f32 v[82:83], v[130:131], v[202:203]
    v_pk_mul_f32 v[90:91], v[138:139], v[202:203]
    v_pk_fma_f32 v[76:77], v[132:133], v[204:205], v[76:77] neg_lo:[0,1,0] neg_hi:[0,1,0]
    v_pk_fma_f32 v[84:85], v[124:125], v[204:205], v[84:85]
    v_pk_fma_f32 v[78:79], v[134:135], v[206:207], v[78:79] neg_lo:[0,1,0] neg_hi:[0,1,0]
    v_pk_fma_f32 v[86:87], v[126:127], v[206:207], v[86:87]
    v_pk_fma_f32 v[80:81], v[136:137], v[208:209], v[80:81] neg_lo:[0,1,0] neg_hi:[0,1,0]
    v_pk_fma_f32 v[88:89], v[128:129], v[208:209], v[88:89]
    v_pk_fma_f32 v[82:83], v[138:139], v[210:211], v[82:83] neg_lo:[0,1,0] neg_hi:[0,1,0]
    v_pk_fma_f32 v[90:91], v[130:131], v[210:211], v[90:91]
    buffer_load_dwordx4 v2, s[40:43], s59 offen offset:1024 sc1 lds
    v_cvt_pk_bf16_f32 v108, v76, v77
    v_cvt_pk_bf16_f32 v109, v78, v79
    v_cvt_pk_bf16_f32 v110, v80, v81
    v_cvt_pk_bf16_f32 v111, v82, v83
    v_cvt_pk_bf16_f32 v112, v84, v85
    v_cvt_pk_bf16_f32 v113, v86, v87
    v_cvt_pk_bf16_f32 v114, v88, v89
    v_cvt_pk_bf16_f32 v115, v90, v91
    ds_write_b64 v140, v[108:109]
    ds_write_b64 v141, v[110:111]
    ds_write_b64 v142, v[112:113]
    ds_write_b64 v143, v[114:115]
    buffer_load_dwordx4 v2, s[40:43], s59 offen offset:2048 sc1 lds
    s_waitcnt lgkmcnt(0)
    s_barrier
    ds_read_b64_tr_b16 v[76:77], v48 offset:8192
    ds_read_b64_tr_b16 v[78:79], v48 offset:10240
    ds_read_b64_tr_b16 v[92:93], v50 offset:8192
    ds_read_b64_tr_b16 v[94:95], v50 offset:10240
    ds_read_b64_tr_b16 v[84:85], v49 offset:8192
    ds_read_b64_tr_b16 v[86:87], v49 offset:10240
    ds_read_b64_tr_b16 v[100:101], v51 offset:8192
    ds_read_b64_tr_b16 v[102:103], v51 offset:10240
    ds_read_b64_tr_b16 v[80:81], v48 offset:12288
    ds_read_b64_tr_b16 v[82:83], v48 offset:14336
    ds_read_b64_tr_b16 v[96:97], v50 offset:12288
    ds_read_b64_tr_b16 v[98:99], v50 offset:14336
    ds_read_b64_tr_b16 v[88:89], v49 offset:12288
    ds_read_b64_tr_b16 v[90:91], v49 offset:14336
    ds_read_b64_tr_b16 v[104:105], v51 offset:12288
    ds_read_b64_tr_b16 v[106:107], v51 offset:14336
    buffer_load_dwordx4 v2, s[40:43], s59 offen offset:3072 sc1 lds
    s_waitcnt lgkmcnt(14)
    v_mfma_f32_16x16x32_bf16 v[124:127], v[76:79], v[148:151], 0
    s_waitcnt lgkmcnt(12)
    v_mfma_f32_16x16x32_bf16 v[132:135], v[92:95], v[148:151], 0
    s_waitcnt lgkmcnt(10)
    v_mfma_f32_16x16x32_bf16 v[128:131], v[84:87], v[148:151], 0
    s_waitcnt lgkmcnt(8)
    v_mfma_f32_16x16x32_bf16 v[136:139], v[100:103], v[148:151], 0
    s_add_u32 m0, s86, 36864
    s_add_u32 s59, s85, 36864
    buffer_load_dwordx4 v2, s[40:43], s59 offen offset:0 sc1 lds
    v_mfma_f32_16x16x32_bf16 v[124:127], v[92:95], v[164:167], v[124:127]
    v_mfma_f32_16x16x32_bf16 v[132:135], v[76:79], v[156:159], v[132:135]
    v_mfma_f32_16x16x32_bf16 v[128:131], v[100:103], v[164:167], v[128:131]
    v_mfma_f32_16x16x32_bf16 v[136:139], v[84:87], v[156:159], v[136:139]
    buffer_load_dwordx4 v2, s[40:43], s59 offen offset:1024 sc1 lds
    s_waitcnt lgkmcnt(6)
    v_mfma_f32_16x16x32_bf16 v[124:127], v[80:83], v[152:155], v[124:127]
    s_waitcnt lgkmcnt(4)
    v_mfma_f32_16x16x32_bf16 v[132:135], v[96:99], v[152:155], v[132:135]
    s_waitcnt lgkmcnt(2)
    v_mfma_f32_16x16x32_bf16 v[128:131], v[88:91], v[152:155], v[128:131]
    s_waitcnt lgkmcnt(0)
    v_mfma_f32_16x16x32_bf16 v[136:139], v[104:107], v[152:155], v[136:139]
    buffer_load_dwordx4 v2, s[40:43], s59 offen offset:2048 sc1 lds
    v_mfma_f32_16x16x32_bf16 v[124:127], v[96:99], v[168:171], v[124:127]
    v_mfma_f32_16x16x32_bf16 v[132:135], v[80:83], v[160:163], v[132:135]
    v_mfma_f32_16x16x32_bf16 v[128:131], v[104:107], v[168:171], v[128:131]
    v_mfma_f32_16x16x32_bf16 v[136:139], v[88:91], v[160:163], v[136:139]
    buffer_load_dwordx4 v2, s[40:43], s59 offen offset:3072 sc1 lds
    s_nop 3
    v_cvt_pk_bf16_f32 v108, v124, v125
    v_cvt_pk_bf16_f32 v112, v132, v133
    v_cvt_pk_bf16_f32 v109, v126, v127
    v_cvt_pk_bf16_f32 v113, v134, v135
    v_cvt_pk_bf16_f32 v110, v128, v129
    v_cvt_pk_bf16_f32 v114, v136, v137
    v_cvt_pk_bf16_f32 v111, v130, v131
    v_cvt_pk_bf16_f32 v115, v138, v139
    v_permlane16_swap_b32 v108, v110
    v_permlane16_swap_b32 v109, v111
    v_permlane16_swap_b32 v112, v114
    v_permlane16_swap_b32 v113, v115
    v_and_b32 v12, 31, v1
    v_lshlrev_b32 v12, 2, v12
    v_lshrrev_b32 v13, 5, v1
    v_lshl_add_u32 v12, v13, 10, v12
    buffer_load_dword v60, v12, s[40:43], s88 offen offset:0 sc1
    buffer_load_dword v61, v12, s[40:43], s88 offen offset:128 sc1
    buffer_load_dword v62, v12, s[40:43], s88 offen offset:256 sc1
    buffer_load_dword v63, v12, s[40:43], s88 offen offset:384 sc1
    buffer_load_dword v64, v12, s[40:43], s88 offen offset:512 sc1
    buffer_load_dword v65, v12, s[40:43], s88 offen offset:640 sc1
    buffer_load_dword v66, v12, s[40:43], s88 offen offset:768 sc1
    buffer_load_dword v67, v12, s[40:43], s88 offen offset:896 sc1
    buffer_store_dwordx4 v[108:111], v146, s[40:43], s87 offen offset:0 sc1
    buffer_store_dwordx4 v[112:115], v146, s[40:43], s87 offen offset:128 sc1
    v_and_b32 v14, 1, v3
    v_lshlrev_b32 v14, 14, v14
    v_lshl_add_u32 v14, v13, 8, v14
    v_lshl_add_u32 v48, v10, 4, v14
    s_add_u32 s7, s90, 16384
    s_cmp_eq_u32 s50, 3
    s_cselect_b32 s7, 1073741824, s7
    s_waitcnt vmcnt(10)
    s_barrier
    ds_read_b128 v[204:207], v48 offset:0
    ds_read_b128 v[208:211], v48 offset:512
    ds_read_b128 v[212:215], v48 offset:1024
    ds_read_b128 v[216:219], v48 offset:1536
    ds_read_b128 v[220:223], v48 offset:2048
    ds_read_b128 v[224:227], v48 offset:2560
    s_waitcnt lgkmcnt(4)
    v_mfma_f32_32x32x16_bf16 v[172:187], a[0:3], v[204:207], 0
    ds_read_b128 v[228:231], v48 offset:3072
    v_mfma_f32_32x32x16_bf16 v[172:187], a[4:7], v[208:211], v[172:187]
    ds_read_b128 v[232:235], v48 offset:3584
    buffer_load_dwordx4 a[184:187], v2, s[40:43], s3 offen offset:2048 sc1
    s_waitcnt lgkmcnt(4)
    v_mfma_f32_32x32x16_bf16 v[172:187], a[8:11], v[212:215], v[172:187]
    ds_read_b128 v[204:207], v48 offset:4096
    v_add_u32 v49, s65, v2
    s_add_u32 s52, s65, 71680
    v_lshl_add_u32 v13, v3, 9, v57
    v_add_u32 v13, s52, v13
    v_mfma_f32_32x32x16_bf16 v[172:187], a[12:15], v[216:219], v[172:187]
    ds_read_b128 v[208:211], v48 offset:4608
    buffer_load_dwordx4 a[188:191], v2, s[40:43], s3 offen offset:3072 sc1
    s_add_u32 s52, s50, 1
    s_and_b32 s52, s52, 3
    s_waitcnt lgkmcnt(4)
    v_mfma_f32_32x32x16_bf16 v[172:187], a[16:19], v[220:223], v[172:187]
    ds_read_b128 v[212:215], v48 offset:5120
    v_xor_b32 v12, s52, v56
    v_lshl_add_u32 v252, v12, 5, v13
    s_lshl_b32 s52, s52, 14
    s_add_u32 s52, s52, 8192
    v_mfma_f32_32x32x16_bf16 v[172:187], a[20:23], v[224:227], v[172:187]
    ds_read_b128 v[216:219], v48 offset:5632
    s_add_u32 s3, s70, 16384
    buffer_load_dwordx4 a[192:195], v2, s[40:43], s3 offen offset:0 sc1
    v_add_u32 v250, s52, v2
    s_add_u32 s52, s50, 2
    s_waitcnt lgkmcnt(4)
    v_mfma_f32_32x32x16_bf16 v[172:187], a[24:27], v[228:231], v[172:187]
    ds_read_b128 v[220:223], v48 offset:6144
    s_and_b32 s52, s52, 3
    v_xor_b32 v12, s52, v56
    v_lshl_add_u32 v253, v12, 5, v13
    s_lshl_b32 s52, s52, 14
    v_mfma_f32_32x32x16_bf16 v[172:187], a[28:31], v[232:235], v[172:187]
    ds_read_b128 v[224:227], v48 offset:6656
    buffer_load_dwordx4 a[196:199], v2, s[40:43], s3 offen offset:1024 sc1
    s_add_u32 s52, s52, 4096
    v_add_u32 v249, s52, v2
    s_waitcnt lgkmcnt(4)
    v_mfma_f32_32x32x16_bf16 v[172:187], a[32:35], v[204:207], v[172:187]
    ds_read_b128 v[228:231], v48 offset:7168
    s_add_u32 s52, s50, 3
    s_and_b32 s52, s52, 3
    v_xor_b32 v12, s52, v56
    v_lshl_add_u32 v254, v12, 5, v13
    v_mfma_f32_32x32x16_bf16 v[172:187], a[36:39], v[208:211], v[172:187]
    ds_read_b128 v[232:235], v48 offset:7680
    buffer_load_dwordx4 a[200:203], v2, s[40:43], s3 offen offset:2048 sc1
    s_lshl_b32 s52, s52, 14
    s_add_u32 s52, s52, 0
    s_waitcnt lgkmcnt(4)
    v_mfma_f32_32x32x16_bf16 v[172:187], a[40:43], v[212:215], v[172:187]
    ds_read_b128 v[204:207], v48 offset:8192
    v_add_u32 v248, s52, v2
    s_add_u32 s52, s50, 4
    s_and_b32 s52, s52, 3
    v_xor_b32 v12, s52, v56
    v_mfma_f32_32x32x16_bf16 v[172:187], a[44:47], v[216:219], v[172:187]
    ds_read_b128 v[208:211], v48 offset:8704
    buffer_load_dwordx4 a[204:207], v2, s[40:43], s3 offen offset:3072 sc1
    v_lshl_add_u32 v255, v12, 5, v13
    v_lshrrev_b32 v12, 3, v1
    s_waitcnt vmcnt(6)
    s_barrier
    s_cmp_lg_u32 s50, 0
    s_cbranch_scc1 Lpub_29
    s_mov_b64 exec, 0xffff
    v_mov_b32 v8, s51
    v_lshlrev_b32 v9, 2, v1
    s_lshr_b32 s95, s92, 1
    s_add_u32 s95, s95, 18219008
    buffer_store_dword v8, v9, s[40:43], s95 offen sc1
    s_mov_b64 exec, -1
Lpub_29:
    s_waitcnt lgkmcnt(4)
    v_mfma_f32_32x32x16_bf16 v[172:187], a[48:51], v[220:223], v[172:187]
    ds_read_b128 v[212:215], v48 offset:9216
    v_and_b32 v13, 0x7f, v44
    v_lshl_add_u32 v50, v12, 7, v13
    v_lshrrev_b32 v12, 1, v3
    v_lshlrev_b32 v12, 10, v12
    v_mfma_f32_32x32x16_bf16 v[172:187], a[52:55], v[224:227], v[172:187]
    ds_read_b128 v[216:219], v48 offset:9728
    s_add_u32 s3, s70, 20480
    buffer_load_dwordx4 a[208:211], v2, s[40:43], s3 offen offset:0 sc1
    v_and_b32 v13, 1, v3
    v_lshl_add_u32 v12, v13, 9, v12
    s_waitcnt lgkmcnt(4)
    v_mfma_f32_32x32x16_bf16 v[172:187], a[56:59], v[228:231], v[172:187]
    ds_read_b128 v[220:223], v48 offset:10240
    v_lshl_add_u32 v51, v10, 4, v12
    s_mul_i32 s4, s48, 56
    s_mul_i32 s52, s50, 14
    s_add_u32 s4, s4, s52
    v_mfma_f32_32x32x16_bf16 v[172:187], a[60:63], v[232:235], v[172:187]
    ds_read_b128 v[224:227], v48 offset:10752
    buffer_load_dwordx4 a[212:215], v2, s[40:43], s3 offen offset:1024 sc1
    s_lshl_b32 s4, s4, 12
    s_add_u32 s4, s4, 10485760
    s_waitcnt lgkmcnt(4)
    v_mfma_f32_32x32x16_bf16 v[172:187], a[64:67], v[204:207], v[172:187]
    ds_read_b128 v[228:231], v48 offset:11264
    s_add_u32 s52, s50, 1
    s_and_b32 s53, s52, 1
    s_lshl_b32 s53, s53, 8
    s_and_b32 s52, s52, 2
    v_mfma_f32_32x32x16_bf16 v[172:187], a[68:71], v[208:211], v[172:187]
    ds_read_b128 v[232:235], v48 offset:11776
    buffer_load_dwordx4 a[216:219], v2, s[40:43], s3 offen offset:2048 sc1
    s_lshl_b32 s52, s52, 10
    s_add_u32 s52, s52, s53
    s_waitcnt lgkmcnt(4)
    v_mfma_f32_32x32x16_bf16 v[172:187], a[72:75], v[212:215], v[172:187]
    ds_read_b128 v[204:207], v48 offset:12288
    s_add_u32 s24, s4, s52
    s_add_u32 s52, s50, 2
    s_and_b32 s53, s52, 1
    s_lshl_b32 s53, s53, 8
    s_and_b32 s52, s52, 2
    v_mfma_f32_32x32x16_bf16 v[172:187], a[76:79], v[216:219], v[172:187]
    ds_read_b128 v[208:211], v48 offset:12800
    buffer_load_dwordx4 a[220:223], v2, s[40:43], s3 offen offset:3072 sc1
    s_lshl_b32 s52, s52, 10
    s_add_u32 s52, s52, s53
    s_waitcnt lgkmcnt(4)
    v_mfma_f32_32x32x16_bf16 v[172:187], a[80:83], v[220:223], v[172:187]
    ds_read_b128 v[212:215], v48 offset:13312
    s_add_u32 s25, s4, s52
    s_add_u32 s52, s50, 3
    s_and_b32 s53, s52, 1
    s_lshl_b32 s53, s53, 8
    s_and_b32 s52, s52, 2
    v_mfma_f32_32x32x16_bf16 v[172:187], a[84:87], v[224:227], v[172:187]
    ds_read_b128 v[216:219], v48 offset:13824
    s_add_u32 s3, s70, 24576
    buffer_load_dwordx4 a[224:227], v2, s[40:43], s3 offen offset:0 sc1
    s_lshl_b32 s52, s52, 10
    s_add_u32 s52, s52, s53
    s_waitcnt lgkmcnt(4)
    v_mfma_f32_32x32x16_bf16 v[172:187], a[88:91], v[228:231], v[172:187]
    ds_read_b128 v[220:223], v48 offset:14336
    s_add_u32 s26, s4, s52
    s_add_u32 s52, s50, 4
    s_and_b32 s53, s52, 1
    s_lshl_b32 s53, s53, 8
    s_and_b32 s52, s52, 2
    v_mfma_f32_32x32x16_bf16 v[172:187], a[92:95], v[232:235], v[172:187]
    ds_read_b128 v[224:227], v48 offset:14848
    buffer_load_dwordx4 a[228:231], v2, s[40:43], s3 offen offset:1024 sc1
    s_lshl_b32 s52, s52, 10
    s_add_u32 s52, s52, s53
    s_add_u32 s27, s4, s52
    s_waitcnt lgkmcnt(4)
    v_mfma_f32_32x32x16_bf16 v[172:187], a[96:99], v[204:207], v[172:187]
    ds_read_b128 v[228:231], v48 offset:15360
    v_add_f32 v60, v60, v62
    v_add_f32 v64, v64, v66
    v_add_f32 v61, v61, v63
    v_add_f32 v65, v65, v67
    v_add_f32 v60, v60, v64
    v_mfma_f32_32x32x16_bf16 v[172:187], a[100:103], v[208:211], v[172:187]
    ds_read_b128 v[232:235], v48 offset:15872
    buffer_load_dwordx4 a[232:235], v2, s[40:43], s3 offen offset:2048 sc1
    v_add_f32 v61, v61, v65
    v_mov_b32 v62, v60
    s_waitcnt lgkmcnt(4)
    v_mfma_f32_32x32x16_bf16 v[172:187], a[104:107], v[212:215], v[172:187]
    ds_read_b128 v[204:207], v48 offset:32768
    v_mov_b32 v63, v61
    v_permlane32_swap_b32 v60, v62
    s_nop 0
    v_permlane32_swap_b32 v61, v63
    v_add_f32 v60, v60, v62
    v_add_f32 v61, v61, v63
    v_mfma_f32_32x32x16_bf16 v[172:187], a[108:111], v[216:219], v[172:187]
    ds_read_b128 v[208:211], v48 offset:33280
    buffer_load_dwordx4 a[236:239], v2, s[40:43], s3 offen offset:3072 sc1
    v_mov_b32 v62, 0x3727c5ac
    v_fmamk_f32 v60, v60, 0x3b000000, v62
    s_waitcnt lgkmcnt(4)
    v_mfma_f32_32x32x16_bf16 v[172:187], a[112:115], v[220:223], v[172:187]
    ds_read_b128 v[212:215], v48 offset:33792
    v_rsq_f32 v60, v60
    v_fmamk_f32 v61, v61, 0x3b000000, v62
    v_rsq_f32 v61, v61
    v_mfma_f32_32x32x16_bf16 v[172:187], a[116:119], v[224:227], v[172:187]
    ds_read_b128 v[216:219], v48 offset:34304
    s_add_u32 s3, s70, 28672
    buffer_load_dwordx4 a[240:243], v2, s[40:43], s3 offen offset:0 sc1
    v_rcp_f32 v73, v60
    v_mul_f32 v71, v60, v60
    s_waitcnt lgkmcnt(4)
    v_mfma_f32_32x32x16_bf16 v[172:187], a[120:123], v[228:231], v[172:187]
    ds_read_b128 v[220:223], v48 offset:34816
    v_mul_f32 v71, v71, v60
    v_mul_f32 v71, 0xbdd2d3e8, v71
    v_mul_f32 v69, 0xc0135761, v60
    v_rcp_f32 v72, v61
    v_mfma_f32_32x32x16_bf16 v[172:187], a[124:127], v[232:235], v[172:187]
    ds_read_b128 v[224:227], v48 offset:35328
    buffer_load_dwordx4 a[244:247], v2, s[40:43], s3 offen offset:1024 sc1
    v_mul_f32 v70, v61, v61
    v_mul_f32 v70, v70, v61
    v_mul_f32 v70, 0xbdd2d3e8, v70
    v_mul_f32 v68, 0xc0135761, v61
    s_waitcnt lgkmcnt(4)
    v_mfma_f32_32x32x16_bf16 v[188:203], a[0:3], v[204:207], 0
    ds_read_b128 v[228:231], v48 offset:35840
    v_mfma_f32_32x32x16_bf16 v[188:203], a[4:7], v[208:211], v[188:203]
    ds_read_b128 v[232:235], v48 offset:36352
    buffer_load_dwordx4 a[248:251], v2, s[40:43], s3 offen offset:2048 sc1
    s_waitcnt lgkmcnt(4)
    v_mfma_f32_32x32x16_bf16 v[188:203], a[8:11], v[212:215], v[188:203]
    ds_read_b128 v[204:207], v48 offset:36864
    v_mul_f32 v236, v172, v172
    v_mul_f32 v237, v173, v173
    v_mul_f32 v238, v174, v174
    v_mul_f32 v239, v175, v175
    v_fma_f32 v236, v236, v71, v69
    v_fma_f32 v237, v237, v71, v69
    v_mfma_f32_32x32x16_bf16 v[188:203], a[12:15], v[216:219], v[188:203]
    ds_read_b128 v[208:211], v48 offset:37376
    buffer_load_dwordx4 a[252:255], v2, s[40:43], s3 offen offset:3072 sc1
    v_fma_f32 v238, v238, v71, v69
    v_fma_f32 v239, v239, v71, v69
    v_mul_f32 v236, v236, v172
    v_mul_f32 v237, v237, v173
    s_waitcnt lgkmcnt(4)
    v_mfma_f32_32x32x16_bf16 v[188:203], a[16:19], v[220:223], v[188:203]
    ds_read_b128 v[212:215], v48 offset:37888
    v_mul_f32 v238, v238, v174
    v_mul_f32 v239, v239, v175
    v_exp_f32 v236, v236
    v_exp_f32 v237, v237
    v_mfma_f32_32x32x16_bf16 v[188:203], a[20:23], v[224:227], v[188:203]
    ds_read_b128 v[216:219], v48 offset:38400
    s_add_u32 s3, s89, 0
    buffer_load_dwordx4 v[76:79], v2, s[40:43], s3 offen offset:0 sc1
    v_exp_f32 v238, v238
    v_exp_f32 v239, v239
    s_waitcnt lgkmcnt(4)
    v_mfma_f32_32x32x16_bf16 v[188:203], a[24:27], v[228:231], v[188:203]
    ds_read_b128 v[220:223], v48 offset:38912
    v_fma_f32 v236, v236, v73, v73
    v_fma_f32 v237, v237, v73, v73
    v_fma_f32 v238, v238, v73, v73
    v_fma_f32 v239, v239, v73, v73
    v_rcp_f32 v236, v236
    v_mfma_f32_32x32x16_bf16 v[188:203], a[28:31], v[232:235], v[188:203]
    ds_read_b128 v[224:227], v48 offset:39424
    buffer_load_dwordx4 v[80:83], v2, s[40:43], s3 offen offset:1024 sc1
    v_rcp_f32 v237, v237
    v_rcp_f32 v238, v238
    s_waitcnt lgkmcnt(4)
    v_mfma_f32_32x32x16_bf16 v[188:203], a[32:35], v[204:207], v[188:203]
    ds_read_b128 v[228:231], v48 offset:39936
    v_rcp_f32 v239, v239
    v_mul_f32 v172, v172, v236
    v_mul_f32 v173, v173, v237
    v_mul_f32 v174, v174, v238
    v_mul_f32 v175, v175, v239
    v_mfma_f32_32x32x16_bf16 v[188:203], a[36:39], v[208:211], v[188:203]
    ds_read_b128 v[232:235], v48 offset:40448
    buffer_load_dwordx4 v[84:87], v2, s[40:43], s3 offen offset:2048 sc1
    v_cvt_pk_bf16_f32 v240, v172, v173
    v_cvt_pk_bf16_f32 v241, v174, v175
    v_mul_f32 v236, v176, v176
    v_mul_f32 v237, v177, v177
    s_waitcnt lgkmcnt(4)
    v_mfma_f32_32x32x16_bf16 v[188:203], a[40:43], v[212:215], v[188:203]
    ds_read_b128 v[204:207], v48 offset:40960
    v_mul_f32 v238, v178, v178
    v_mul_f32 v239, v179, v179
    v_fma_f32 v236, v236, v71, v69
    v_fma_f32 v237, v237, v71, v69
    v_fma_f32 v238, v238, v71, v69
    v_fma_f32 v239, v239, v71, v69
    v_mfma_f32_32x32x16_bf16 v[188:203], a[44:47], v[216:219], v[188:203]
    ds_read_b128 v[208:211], v48 offset:41472
    buffer_load_dwordx4 v[88:91], v2, s[40:43], s3 offen offset:3072 sc1
    v_mul_f32 v236, v236, v176
    v_mul_f32 v237, v237, v177
    v_mul_f32 v238, v238, v178
    v_mul_f32 v239, v239, v179
    s_waitcnt lgkmcnt(4)
    v_mfma_f32_32x32x16_bf16 v[188:203], a[48:51], v[220:223], v[188:203]
    ds_read_b128 v[212:215], v48 offset:41984
    v_exp_f32 v236, v236
    v_exp_f32 v237, v237
    v_exp_f32 v238, v238
    v_mfma_f32_32x32x16_bf16 v[188:203], a[52:55], v[224:227], v[188:203]
    ds_read_b128 v[216:219], v48 offset:42496
    s_add_u32 s3, s89, 4096
    buffer_load_dwordx4 v[92:95], v2, s[40:43], s3 offen offset:0 sc1
    v_exp_f32 v239, v239
    v_fma_f32 v236, v236, v73, v73
    v_fma_f32 v237, v237, v73, v73
    s_waitcnt lgkmcnt(4)
    v_mfma_f32_32x32x16_bf16 v[188:203], a[56:59], v[228:231], v[188:203]
    ds_read_b128 v[220:223], v48 offset:43008
    v_fma_f32 v238, v238, v73, v73
    v_fma_f32 v239, v239, v73, v73
    v_rcp_f32 v236, v236
    v_rcp_f32 v237, v237
    v_mfma_f32_32x32x16_bf16 v[188:203], a[60:63], v[232:235], v[188:203]
    ds_read_b128 v[224:227], v48 offset:43520
    buffer_load_dwordx4 v[96:99], v2, s[40:43], s3 offen offset:1024 sc1
    v_rcp_f32 v238, v238
    v_rcp_f32 v239, v239
    s_waitcnt lgkmcnt(4)
    v_mfma_f32_32x32x16_bf16 v[188:203], a[64:67], v[204:207], v[188:203]
    ds_read_b128 v[228:231], v48 offset:44032
    v_mul_f32 v176, v176, v236
    v_mul_f32 v177, v177, v237
    v_mul_f32 v178, v178, v238
    v_mul_f32 v179, v179, v239
    v_cvt_pk_bf16_f32 v242, v176, v177
    v_cvt_pk_bf16_f32 v243, v178, v179
    v_mfma_f32_32x32x16_bf16 v[188:203], a[68:71], v[208:211], v[188:203]
    ds_read_b128 v[232:235], v48 offset:44544
    buffer_load_dwordx4 v[100:103], v2, s[40:43], s3 offen offset:2048 sc1
    v_mul_f32 v236, v180, v180
    v_mul_f32 v237, v181, v181
    v_mul_f32 v238, v182, v182
    v_mul_f32 v239, v183, v183
    s_waitcnt lgkmcnt(4)
    v_mfma_f32_32x32x16_bf16 v[188:203], a[72:75], v[212:215], v[188:203]
    ds_read_b128 v[204:207], v48 offset:45056
    v_fma_f32 v236, v236, v71, v69
    v_fma_f32 v237, v237, v71, v69
    v_fma_f32 v238, v238, v71, v69
    v_fma_f32 v239, v239, v71, v69
    v_mul_f32 v236, v236, v180
    v_mul_f32 v237, v237, v181
    v_mfma_f32_32x32x16_bf16 v[188:203], a[76:79], v[216:219], v[188:203]
    ds_read_b128 v[208:211], v48 offset:45568
    buffer_load_dwordx4 v[104:107], v2, s[40:43], s3 offen offset:3072 sc1
    v_mul_f32 v238, v238, v182
    v_mul_f32 v239, v239, v183
    v_exp_f32 v236, v236
    s_waitcnt lgkmcnt(4)
    v_mfma_f32_32x32x16_bf16 v[188:203], a[80:83], v[220:223], v[188:203]
    ds_read_b128 v[212:215], v48 offset:46080
    v_exp_f32 v237, v237
    v_exp_f32 v238, v238
    v_exp_f32 v239, v239
    v_mfma_f32_32x32x16_bf16 v[188:203], a[84:87], v[224:227], v[188:203]
    ds_read_b128 v[216:219], v48 offset:46592
    s_add_u32 s3, s89, 8192
    buffer_load_dwordx4 v[108:111], v2, s[40:43], s3 offen offset:0 sc1
    v_fma_f32 v236, v236, v73, v73
    v_fma_f32 v237, v237, v73, v73
    v_fma_f32 v238, v238, v73, v73
    v_fma_f32 v239, v239, v73, v73
    s_waitcnt lgkmcnt(4)
    v_mfma_f32_32x32x16_bf16 v[188:203], a[88:91], v[228:231], v[188:203]
    ds_read_b128 v[220:223], v48 offset:47104
    v_rcp_f32 v236, v236
    v_rcp_f32 v237, v237
    v_rcp_f32 v238, v238
    v_mfma_f32_32x32x16_bf16 v[188:203], a[92:95], v[232:235], v[188:203]
    ds_read_b128 v[224:227], v48 offset:47616
    buffer_load_dwordx4 v[112:115], v2, s[40:43], s3 offen offset:1024 sc1
    v_rcp_f32 v239, v239
    v_mul_f32 v180, v180, v236
    v_mul_f32 v181, v181, v237
    s_waitcnt lgkmcnt(4)
    v_mfma_f32_32x32x16_bf16 v[188:203], a[96:99], v[204:207], v[188:203]
    ds_read_b128 v[228:231], v48 offset:48128
    v_mul_f32 v182, v182, v238
    v_mul_f32 v183, v183, v239
    v_cvt_pk_bf16_f32 v244, v180, v181
    v_cvt_pk_bf16_f32 v245, v182, v183
    v_mul_f32 v236, v184, v184
    v_mul_f32 v237, v185, v185
    v_mfma_f32_32x32x16_bf16 v[188:203], a[100:103], v[208:211], v[188:203]
    ds_read_b128 v[232:235], v48 offset:48640
    buffer_load_dwordx4 v[116:119], v2, s[40:43], s3 offen offset:2048 sc1
    v_mul_f32 v238, v186, v186
    v_mul_f32 v239, v187, v187
    v_fma_f32 v236, v236, v71, v69
    v_fma_f32 v237, v237, v71, v69
    s_waitcnt lgkmcnt(4)
    v_mfma_f32_32x32x16_bf16 v[188:203], a[104:107], v[212:215], v[188:203]
    ds_read_b128 v[204:207], v48 offset:0
    v_fma_f32 v238, v238, v71, v69
    v_fma_f32 v239, v239, v71, v69
    v_mul_f32 v236, v236, v184
    v_mul_f32 v237, v237, v185
    v_mul_f32 v238, v238, v186
    v_mul_f32 v239, v239, v187
    v_mfma_f32_32x32x16_bf16 v[188:203], a[108:111], v[216:219], v[188:203]
    ds_read_b128 v[208:211], v48 offset:512
    buffer_load_dwordx4 v[120:123], v2, s[40:43], s3 offen offset:3072 sc1
    v_exp_f32 v236, v236
    v_exp_f32 v237, v237
    s_waitcnt lgkmcnt(4)
    v_mfma_f32_32x32x16_bf16 v[188:203], a[112:115], v[220:223], v[188:203]
    ds_read_b128 v[212:215], v48 offset:1024
    v_exp_f32 v238, v238
    v_exp_f32 v239, v239
    v_fma_f32 v236, v236, v73, v73
    v_fma_f32 v237, v237, v73, v73
    v_fma_f32 v238, v238, v73, v73
    v_mfma_f32_32x32x16_bf16 v[188:203], a[116:119], v[224:227], v[188:203]
    ds_read_b128 v[216:219], v48 offset:1536
    s_add_u32 s3, s89, 12288
    buffer_load_dwordx4 v[124:127], v2, s[40:43], s3 offen offset:0 sc1
    v_fma_f32 v239, v239, v73, v73
    v_rcp_f32 v236, v236
    s_waitcnt lgkmcnt(4)
    v_mfma_f32_32x32x16_bf16 v[188:203], a[120:123], v[228:231], v[188:203]
    ds_read_b128 v[220:223], v48 offset:2048
    v_rcp_f32 v237, v237
    v_rcp_f32 v238, v238
    v_rcp_f32 v239, v239
    v_mul_f32 v184, v184, v236
    v_mul_f32 v185, v185, v237
    v_mfma_f32_32x32x16_bf16 v[188:203], a[124:127], v[232:235], v[188:203]
    ds_read_b128 v[224:227], v48 offset:2560
    buffer_load_dwordx4 v[128:131], v2, s[40:43], s3 offen offset:1024 sc1
    v_mul_f32 v186, v186, v238
    v_mul_f32 v187, v187, v239
    v_cvt_pk_bf16_f32 v246, v184, v185
    v_cvt_pk_bf16_f32 v247, v186, v187
    buffer_store_dwordx4 v[240:243], v2, s[40:43], s90 offen offset:0 sc1
    buffer_store_dwordx4 v[244:247], v2, s[40:43], s90 offen offset:1024 sc1
    s_waitcnt lgkmcnt(4)
    v_mfma_f32_32x32x16_bf16 v[172:187], a[128:131], v[204:207], 0
    ds_read_b128 v[228:231], v48 offset:3072
    v_mfma_f32_32x32x16_bf16 v[172:187], a[132:135], v[208:211], v[172:187]
    ds_read_b128 v[232:235], v48 offset:3584
    buffer_load_dwordx4 v[132:135], v2, s[40:43], s3 offen offset:2048 sc1
    s_waitcnt lgkmcnt(4)
    v_mfma_f32_32x32x16_bf16 v[172:187], a[136:139], v[212:215], v[172:187]
    ds_read_b128 v[204:207], v48 offset:4096
    v_mul_f32 v236, v188, v188
    v_mul_f32 v237, v189, v189
    v_mul_f32 v238, v190, v190
    v_mul_f32 v239, v191, v191
    v_fma_f32 v236, v236, v70, v68
    v_fma_f32 v237, v237, v70, v68
    v_fma_f32 v238, v238, v70, v68
    v_fma_f32 v239, v239, v70, v68
    v_mfma_f32_32x32x16_bf16 v[172:187], a[140:143], v[216:219], v[172:187]
    ds_read_b128 v[208:211], v48 offset:4608
    buffer_load_dwordx4 v[136:139], v2, s[40:43], s3 offen offset:3072 sc1
    v_mul_f32 v236, v236, v188
    v_mul_f32 v237, v237, v189
    v_mul_f32 v238, v238, v190
    v_mul_f32 v239, v239, v191
    v_exp_f32 v236, v236
    s_waitcnt lgkmcnt(4)
    v_mfma_f32_32x32x16_bf16 v[172:187], a[144:147], v[220:223], v[172:187]
    ds_read_b128 v[212:215], v48 offset:5120
    v_exp_f32 v237, v237
    v_exp_f32 v238, v238
    v_exp_f32 v239, v239
    v_fma_f32 v236, v236, v72, v72
    v_fma_f32 v237, v237, v72, v72
    v_mfma_f32_32x32x16_bf16 v[172:187], a[148:151], v[224:227], v[172:187]
    ds_read_b128 v[216:219], v48 offset:5632
    s_add_u32 s3, s89, 28672
    buffer_load_dwordx4 v[140:143], v2, s[40:43], s3 offen offset:0 sc1
    v_fma_f32 v238, v238, v72, v72
    v_fma_f32 v239, v239, v72, v72
    v_rcp_f32 v236, v236
    v_rcp_f32 v237, v237
    s_waitcnt lgkmcnt(4)
    v_mfma_f32_32x32x16_bf16 v[172:187], a[152:155], v[228:231], v[172:187]
    ds_read_b128 v[220:223], v48 offset:6144
    v_rcp_f32 v238, v238
    v_rcp_f32 v239, v239
    v_mul_f32 v188, v188, v236
    v_mul_f32 v189, v189, v237
    v_mul_f32 v190, v190, v238
    v_mul_f32 v191, v191, v239
    v_mfma_f32_32x32x16_bf16 v[172:187], a[156:159], v[232:235], v[172:187]
    ds_read_b128 v[224:227], v48 offset:6656
    buffer_load_dwordx4 v[144:147], v2, s[40:43], s3 offen offset:1024 sc1
    v_cvt_pk_bf16_f32 v240, v188, v189
    v_cvt_pk_bf16_f32 v241, v190, v191
    v_mul_f32 v236, v192, v192
    v_mul_f32 v237, v193, v193
    v_mul_f32 v238, v194, v194
    v_mul_f32 v239, v195, v195
    s_waitcnt lgkmcnt(4)
    v_mfma_f32_32x32x16_bf16 v[172:187], a[160:163], v[204:207], v[172:187]
    ds_read_b128 v[228:231], v48 offset:7168
    v_fma_f32 v236, v236, v70, v68
    v_fma_f32 v237, v237, v70, v68
    v_fma_f32 v238, v238, v70, v68
    v_fma_f32 v239, v239, v70, v68
    v_mul_f32 v236, v236, v192
    v_mul_f32 v237, v237, v193
    v_mul_f32 v238, v238, v194
    v_mul_f32 v239, v239, v195
    v_mfma_f32_32x32x16_bf16 v[172:187], a[164:167], v[208:211], v[172:187]
    ds_read_b128 v[232:235], v48 offset:7680
    buffer_load_dwordx4 v[148:151], v2, s[40:43], s3 offen offset:2048 sc1
    v_exp_f32 v236, v236
    v_exp_f32 v237, v237
    v_exp_f32 v238, v238
    s_waitcnt lgkmcnt(4)
    v_mfma_f32_32x32x16_bf16 v[172:187], a[168:171], v[212:215], v[172:187]
    ds_read_b128 v[204:207], v48 offset:8192
    v_exp_f32 v239, v239
    v_fma_f32 v236, v236, v72, v72
    v_fma_f32 v237, v237, v72, v72
    v_fma_f32 v238, v238, v72, v72
    v_fma_f32 v239, v239, v72, v72
    v_rcp_f32 v236, v236
    v_mfma_f32_32x32x16_bf16 v[172:187], a[172:175], v[216:219], v[172:187]
    ds_read_b128 v[208:211], v48 offset:8704
    buffer_load_dwordx4 v[152:155], v2, s[40:43], s3 offen offset:3072 sc1
    v_rcp_f32 v237, v237
    v_rcp_f32 v238, v238
    v_rcp_f32 v239, v239
    s_waitcnt lgkmcnt(4)
    v_mfma_f32_32x32x16_bf16 v[172:187], a[176:179], v[220:223], v[172:187]
    ds_read_b128 v[212:215], v48 offset:9216
    v_mul_f32 v192, v192, v236
    v_mul_f32 v193, v193, v237
    v_mul_f32 v194, v194, v238
    v_mul_f32 v195, v195, v239
    v_cvt_pk_bf16_f32 v242, v192, v193
    v_cvt_pk_bf16_f32 v243, v194, v195
    v_mul_f32 v236, v196, v196
    v_mul_f32 v237, v197, v197
    v_mfma_f32_32x32x16_bf16 v[172:187], a[180:183], v[224:227], v[172:187]
    ds_read_b128 v[216:219], v48 offset:9728
    s_add_u32 s3, s89, 32768
    buffer_load_dwordx4 v[156:159], v2, s[40:43], s3 offen offset:0 sc1
    v_mul_f32 v238, v198, v198
    v_mul_f32 v239, v199, v199
    v_fma_f32 v236, v236, v70, v68
    v_fma_f32 v237, v237, v70, v68
    v_fma_f32 v238, v238, v70, v68
    v_fma_f32 v239, v239, v70, v68
    s_waitcnt lgkmcnt(4)
    s_waitcnt vmcnt(40)
    v_mfma_f32_32x32x16_bf16 v[172:187], a[184:187], v[228:231], v[172:187]
    ds_read_b128 v[220:223], v48 offset:10240
    v_mul_f32 v236, v236, v196
    v_mul_f32 v237, v237, v197
    v_mul_f32 v238, v238, v198
    v_mul_f32 v239, v239, v199
    v_exp_f32 v236, v236
    v_exp_f32 v237, v237
    s_waitcnt vmcnt(39)
    v_mfma_f32_32x32x16_bf16 v[172:187], a[188:191], v[232:235], v[172:187]
    ds_read_b128 v[224:227], v48 offset:10752
    buffer_load_dwordx4 v[160:163], v2, s[40:43], s3 offen offset:1024 sc1
    v_exp_f32 v238, v238
    v_exp_f32 v239, v239
    v_fma_f32 v236, v236, v72, v72
    v_fma_f32 v237, v237, v72, v72
    v_fma_f32 v238, v238, v72, v72
    s_waitcnt lgkmcnt(4)
    s_waitcnt vmcnt(39)
    v_mfma_f32_32x32x16_bf16 v[172:187], a[192:195], v[204:207], v[172:187]
    ds_read_b128 v[228:231], v48 offset:11264
    v_fma_f32 v239, v239, v72, v72
    v_rcp_f32 v236, v236
    v_rcp_f32 v237, v237
    v_rcp_f32 v238, v238
    v_rcp_f32 v239, v239
    s_waitcnt vmcnt(38)
    v_mfma_f32_32x32x16_bf16 v[172:187], a[196:199], v[208:211], v[172:187]
    ds_read_b128 v[232:235], v48 offset:11776
    buffer_load_dwordx4 v[164:167], v2, s[40:43], s3 offen offset:2048 sc1
    v_mul_f32 v196, v196, v236
    v_mul_f32 v197, v197, v237
    v_mul_f32 v198, v198, v238
    v_mul_f32 v199, v199, v239
    v_cvt_pk_bf16_f32 v244, v196, v197
    v_cvt_pk_bf16_f32 v245, v198, v199
    s_waitcnt lgkmcnt(4)
    s_waitcnt vmcnt(38)
    v_mfma_f32_32x32x16_bf16 v[172:187], a[200:203], v[212:215], v[172:187]
    ds_read_b128 v[204:207], v48 offset:12288
    v_mul_f32 v236, v200, v200
    v_mul_f32 v237, v201, v201
    v_mul_f32 v238, v202, v202
    v_mul_f32 v239, v203, v203
    v_fma_f32 v236, v236, v70, v68
    v_fma_f32 v237, v237, v70, v68
    v_fma_f32 v238, v238, v70, v68
    v_fma_f32 v239, v239, v70, v68
    v_mul_f32 v236, v236, v200
    s_waitcnt vmcnt(37)
    v_mfma_f32_32x32x16_bf16 v[172:187], a[204:207], v[216:219], v[172:187]
    ds_read_b128 v[208:211], v48 offset:12800
    buffer_load_dwordx4 v[168:171], v2, s[40:43], s3 offen offset:3072 sc1
    v_mul_f32 v237, v237, v201
    v_mul_f32 v238, v238, v202
    v_mul_f32 v239, v239, v203
    v_exp_f32 v236, v236
    v_exp_f32 v237, v237
    s_waitcnt lgkmcnt(4)
    s_waitcnt vmcnt(37)
    v_mfma_f32_32x32x16_bf16 v[172:187], a[208:211], v[220:223], v[172:187]
    ds_read_b128 v[212:215], v48 offset:13312
    s_mov_b32 s57, 18219008
    v_lshlrev_b32 v11, 6, v0
    buffer_load_dword v4, v11, s[40:43], s57 offen sc1
    v_exp_f32 v238, v238
    v_exp_f32 v239, v239
    v_fma_f32 v236, v236, v72, v72
    v_fma_f32 v237, v237, v72, v72
    v_fma_f32 v238, v238, v72, v72
    v_fma_f32 v239, v239, v72, v72
    s_waitcnt vmcnt(37)
    v_mfma_f32_32x32x16_bf16 v[172:187], a[212:215], v[224:227], v[172:187]
    ds_read_b128 v[216:219], v48 offset:13824
    s_add_u32 s3, s89, 36864
    buffer_load_dwordx4 a[0:3], v2, s[40:43], s3 offen offset:0 sc1
    v_rcp_f32 v236, v236
    v_rcp_f32 v237, v237
    v_rcp_f32 v238, v238
    s_waitcnt lgkmcnt(4)
    s_waitcnt vmcnt(37)
    v_mfma_f32_32x32x16_bf16 v[172:187], a[216:219], v[228:231], v[172:187]
    ds_read_b128 v[220:223], v48 offset:14336
    v_rcp_f32 v239, v239
    v_mul_f32 v200, v200, v236
    v_mul_f32 v201, v201, v237
    v_mul_f32 v202, v202, v238
    v_mul_f32 v203, v203, v239
    v_cvt_pk_bf16_f32 v246, v200, v201
    v_cvt_pk_bf16_f32 v247, v202, v203
    buffer_store_dwordx4 v[240:243], v2, s[40:43], s90 offen offset:2048 sc1
    buffer_store_dwordx4 v[244:247], v2, s[40:43], s90 offen offset:3072 sc1
    s_waitcnt vmcnt(38)
    v_mfma_f32_32x32x16_bf16 v[172:187], a[220:223], v[232:235], v[172:187]
    ds_read_b128 v[224:227], v48 offset:14848
    buffer_load_dwordx4 a[4:7], v2, s[40:43], s3 offen offset:1024 sc1
    s_waitcnt lgkmcnt(4)
    s_waitcnt vmcnt(38)
    v_mfma_f32_32x32x16_bf16 v[172:187], a[224:227], v[204:207], v[172:187]
    ds_read_b128 v[228:231], v48 offset:15360
    s_waitcnt vmcnt(37)
    v_mfma_f32_32x32x16_bf16 v[172:187], a[228:231], v[208:211], v[172:187]
    ds_read_b128 v[232:235], v48 offset:15872
    buffer_load_dwordx4 a[8:11], v2, s[40:43], s3 offen offset:2048 sc1
    s_waitcnt lgkmcnt(4)
    s_waitcnt vmcnt(37)
    v_mfma_f32_32x32x16_bf16 v[172:187], a[232:235], v[212:215], v[172:187]
    ds_read_b128 v[204:207], v48 offset:32768
    s_waitcnt vmcnt(36)
    v_mfma_f32_32x32x16_bf16 v[172:187], a[236:239], v[216:219], v[172:187]
    ds_read_b128 v[208:211], v48 offset:33280
    buffer_load_dwordx4 a[12:15], v2, s[40:43], s3 offen offset:3072 sc1
    s_waitcnt lgkmcnt(4)
    s_waitcnt vmcnt(36)
    v_mfma_f32_32x32x16_bf16 v[172:187], a[240:243], v[220:223], v[172:187]
    ds_read_b128 v[212:215], v48 offset:33792
    s_waitcnt vmcnt(35)
    v_mfma_f32_32x32x16_bf16 v[172:187], a[244:247], v[224:227], v[172:187]
    ds_read_b128 v[216:219], v48 offset:34304
    s_add_u32 s3, s89, 40960
    buffer_load_dwordx4 a[16:19], v2, s[40:43], s3 offen offset:0 sc1
    s_waitcnt lgkmcnt(4)
    s_waitcnt vmcnt(35)
    v_mfma_f32_32x32x16_bf16 v[172:187], a[248:251], v[228:231], v[172:187]
    ds_read_b128 v[220:223], v48 offset:34816
    s_waitcnt vmcnt(34)
    v_mfma_f32_32x32x16_bf16 v[172:187], a[252:255], v[232:235], v[172:187]
    ds_read_b128 v[224:227], v48 offset:35328
    buffer_load_dwordx4 a[20:23], v2, s[40:43], s3 offen offset:1024 sc1
    s_waitcnt lgkmcnt(4)
    v_mfma_f32_32x32x16_bf16 v[188:203], a[128:131], v[204:207], 0
    ds_read_b128 v[228:231], v48 offset:35840
    v_mfma_f32_32x32x16_bf16 v[188:203], a[132:135], v[208:211], v[188:203]
    ds_read_b128 v[232:235], v48 offset:36352
    buffer_load_dwordx4 a[24:27], v2, s[40:43], s3 offen offset:2048 sc1
    s_waitcnt lgkmcnt(4)
    v_mfma_f32_32x32x16_bf16 v[188:203], a[136:139], v[212:215], v[188:203]
    ds_read_b128 v[204:207], v48 offset:36864
    s_nop 0
    v_mul_f32 v236, v172, v172
    v_mul_f32 v237, v173, v173
    v_mul_f32 v238, v174, v174
    v_mul_f32 v239, v175, v175
    v_fma_f32 v236, v236, v71, v69
    v_fma_f32 v237, v237, v71, v69
    v_mfma_f32_32x32x16_bf16 v[188:203], a[140:143], v[216:219], v[188:203]
    ds_read_b128 v[208:211], v48 offset:37376
    buffer_load_dwordx4 a[28:31], v2, s[40:43], s3 offen offset:3072 sc1
    v_fma_f32 v238, v238, v71, v69
    v_fma_f32 v239, v239, v71, v69
    v_mul_f32 v236, v236, v172
    v_mul_f32 v237, v237, v173
    s_waitcnt lgkmcnt(4)
    v_mfma_f32_32x32x16_bf16 v[188:203], a[144:147], v[220:223], v[188:203]
    ds_read_b128 v[212:215], v48 offset:37888
    v_mul_f32 v238, v238, v174
    v_mul_f32 v239, v239, v175
    v_exp_f32 v236, v236
    v_exp_f32 v237, v237
    v_mfma_f32_32x32x16_bf16 v[188:203], a[148:151], v[224:227], v[188:203]
    ds_read_b128 v[216:219], v48 offset:38400
    s_add_u32 s3, s89, 16384
    buffer_load_dwordx4 a[32:35], v2, s[40:43], s3 offen offset:0 sc1
    v_exp_f32 v238, v238
    v_exp_f32 v239, v239
    s_waitcnt lgkmcnt(4)
    v_mfma_f32_32x32x16_bf16 v[188:203], a[152:155], v[228:231], v[188:203]
    ds_read_b128 v[220:223], v48 offset:38912
    v_fma_f32 v236, v236, v73, v73
    v_fma_f32 v237, v237, v73, v73
    v_fma_f32 v238, v238, v73, v73
    v_fma_f32 v239, v239, v73, v73
    v_rcp_f32 v236, v236
    v_mfma_f32_32x32x16_bf16 v[188:203], a[156:159], v[232:235], v[188:203]
    ds_read_b128 v[224:227], v48 offset:39424
    buffer_load_dwordx4 a[36:39], v2, s[40:43], s3 offen offset:1024 sc1
    v_rcp_f32 v237, v237
    v_rcp_f32 v238, v238
    s_mov_b32 s56, 0
    s_waitcnt vmcnt(12)
    v_cmp_ne_u32 vcc, s51, v4
    s_nop 0
    s_cbranch_vccz Ldone_32
Lpoll_31:
    s_sleep 4
    buffer_load_dword v4, v11, s[40:43], s57 offen sc1
    s_add_u32 s56, s56, 1
    s_cmp_gt_u32 s56, 0x40000
    s_cbranch_scc1 Ldone_32
    s_waitcnt vmcnt(0)
    v_cmp_ne_u32 vcc, s51, v4
    s_nop 0
    s_cbranch_vccz Ldone_32
    s_branch Lpoll_31
Ldone_32:
    s_waitcnt vmcnt(9)
    s_barrier
    s_cmp_lg_u32 s50, 0
    s_cbranch_scc1 Lpub_34
    s_mov_b64 exec, 0xffff
    v_mov_b32 v8, s51
    v_lshlrev_b32 v9, 2, v1
    s_add_u32 s95, s92, 18284544
    buffer_store_dword v8, v9, s[40:43], s95 offen sc1
    s_mov_b64 exec, -1
Lpub_34:
    s_waitcnt lgkmcnt(4)
    v_mfma_f32_32x32x16_bf16 v[188:203], a[160:163], v[204:207], v[188:203]
    ds_read_b128 v[228:231], v48 offset:39936
    v_rcp_f32 v239, v239
    v_mul_f32 v172, v172, v236
    v_mul_f32 v173, v173, v237
    v_mul_f32 v174, v174, v238
    v_mul_f32 v175, v175, v239
    v_mfma_f32_32x32x16_bf16 v[188:203], a[164:167], v[208:211], v[188:203]
    ds_read_b128 v[232:235], v48 offset:40448
    s_add_u32 m0, s65, 71680
    s_add_u32 s59, s64, 8388608
    buffer_load_dwordx4 v50, s[40:43], s59 offen offset:0 sc1 lds
    v_cvt_pk_bf16_f32 v240, v172, v173
    v_cvt_pk_bf16_f32 v241, v174, v175
    v_mul_f32 v236, v176, v176
    v_mul_f32 v237, v177, v177
    s_waitcnt lgkmcnt(4)
    v_mfma_f32_32x32x16_bf16 v[188:203], a[168:171], v[212:215], v[188:203]
    ds_read_b128 v[204:207], v48 offset:40960
    v_mul_f32 v238, v178, v178
    v_mul_f32 v239, v179, v179
    v_fma_f32 v236, v236, v71, v69
    v_fma_f32 v237, v237, v71, v69
    v_fma_f32 v238, v238, v71, v69
    v_fma_f32 v239, v239, v71, v69
    v_mfma_f32_32x32x16_bf16 v[188:203], a[172:175], v[216:219], v[188:203]
    ds_read_b128 v[208:211], v48 offset:41472
    buffer_load_dwordx4 v50, s[40:43], s59 offen offset:1024 sc1 lds
    v_mul_f32 v236, v236, v176
    v_mul_f32 v237, v237, v177
    v_mul_f32 v238, v238, v178
    v_mul_f32 v239, v239, v179
    s_waitcnt lgkmcnt(4)
    v_mfma_f32_32x32x16_bf16 v[188:203], a[176:179], v[220:223], v[188:203]
    ds_read_b128 v[212:215], v48 offset:41984
    v_exp_f32 v236, v236
    v_exp_f32 v237, v237
    v_exp_f32 v238, v238
    v_mfma_f32_32x32x16_bf16 v[188:203], a[180:183], v[224:227], v[188:203]
    ds_read_b128 v[216:219], v48 offset:42496
    buffer_load_dwordx4 v50, s[40:43], s59 offen offset:2048 sc1 lds
    v_exp_f32 v239, v239
    v_fma_f32 v236, v236, v73, v73
    v_fma_f32 v237, v237, v73, v73
    s_waitcnt lgkmcnt(4)
    v_mfma_f32_32x32x16_bf16 v[188:203], a[184:187], v[228:231], v[188:203]
    ds_read_b128 v[220:223], v48 offset:43008
    v_fma_f32 v238, v238, v73, v73
    v_fma_f32 v239, v239, v73, v73
    v_rcp_f32 v236, v236
    v_rcp_f32 v237, v237
    v_mfma_f32_32x32x16_bf16 v[188:203], a[188:191], v[232:235], v[188:203]
    ds_read_b128 v[224:227], v48 offset:43520
    buffer_load_dwordx4 v50, s[40:43], s59 offen offset:3072 sc1 lds
    v_rcp_f32 v238, v238
    v_rcp_f32 v239, v239
    s_waitcnt lgkmcnt(4)
    v_mfma_f32_32x32x16_bf16 v[188:203], a[192:195], v[204:207], v[188:203]
    ds_read_b128 v[228:231], v48 offset:44032
    v_mul_f32 v176, v176, v236
    v_mul_f32 v177, v177, v237
    v_mul_f32 v178, v178, v238
    v_mul_f32 v179, v179, v239
    v_cvt_pk_bf16_f32 v242, v176, v177
    v_cvt_pk_bf16_f32 v243, v178, v179
    v_mfma_f32_32x32x16_bf16 v[188:203], a[196:199], v[208:211], v[188:203]
    ds_read_b128 v[232:235], v48 offset:44544
    s_add_u32 m0, s65, 75776
    s_add_u32 s59, s64, 8392704
    buffer_load_dwordx4 v50, s[40:43], s59 offen offset:0 sc1 lds
    v_mul_f32 v236, v180, v180
    v_mul_f32 v237, v181, v181
    v_mul_f32 v238, v182, v182
    v_mul_f32 v239, v183, v183
    s_waitcnt lgkmcnt(4)
    v_mfma_f32_32x32x16_bf16 v[188:203], a[200:203], v[212:215], v[188:203]
    ds_read_b128 v[204:207], v48 offset:45056
    v_fma_f32 v236, v236, v71, v69
    v_fma_f32 v237, v237, v71, v69
    v_fma_f32 v238, v238, v71, v69
    v_fma_f32 v239, v239, v71, v69
    v_mul_f32 v236, v236, v180
    v_mul_f32 v237, v237, v181
    v_mfma_f32_32x32x16_bf16 v[188:203], a[204:207], v[216:219], v[188:203]
    ds_read_b128 v[208:211], v48 offset:45568
    buffer_load_dwordx4 v50, s[40:43], s59 offen offset:1024 sc1 lds
    v_mul_f32 v238, v238, v182
    v_mul_f32 v239, v239, v183
    v_exp_f32 v236, v236
    s_waitcnt lgkmcnt(4)
    v_mfma_f32_32x32x16_bf16 v[188:203], a[208:211], v[220:223], v[188:203]
    ds_read_b128 v[212:215], v48 offset:46080
    v_exp_f32 v237, v237
    v_exp_f32 v238, v238
    v_exp_f32 v239, v239
    v_mfma_f32_32x32x16_bf16 v[188:203], a[212:215], v[224:227], v[188:203]
    ds_read_b128 v[216:219], v48 offset:46592
    buffer_load_dwordx4 v50, s[40:43], s59 offen offset:2048 sc1 lds
    v_fma_f32 v236, v236, v73, v73
    v_fma_f32 v237, v237, v73, v73
    v_fma_f32 v238, v238, v73, v73
    v_fma_f32 v239, v239, v73, v73
    s_waitcnt lgkmcnt(4)
    v_mfma_f32_32x32x16_bf16 v[188:203], a[216:219], v[228:231], v[188:203]
    ds_read_b128 v[220:223], v48 offset:47104
    v_rcp_f32 v236, v236
    v_rcp_f32 v237, v237
    v_rcp_f32 v238, v238
    v_mfma_f32_32x32x16_bf16 v[188:203], a[220:223], v[232:235], v[188:203]
    ds_read_b128 v[224:227], v48 offset:47616
    buffer_load_dwordx4 v50, s[40:43], s59 offen offset:3072 sc1 lds
    v_rcp_f32 v239, v239
    v_mul_f32 v180, v180, v236
    v_mul_f32 v181, v181, v237
    s_waitcnt lgkmcnt(4)
    v_mfma_f32_32x32x16_bf16 v[188:203], a[224:227], v[204:207], v[188:203]
    ds_read_b128 v[228:231], v48 offset:48128
    v_mul_f32 v182, v182, v238
    v_mul_f32 v183, v183, v239
    v_cvt_pk_bf16_f32 v244, v180, v181
    v_cvt_pk_bf16_f32 v245, v182, v183
    v_mul_f32 v236, v184, v184
    v_mul_f32 v237, v185, v185
    v_mfma_f32_32x32x16_bf16 v[188:203], a[228:231], v[208:211], v[188:203]
    ds_read_b128 v[232:235], v48 offset:48640
    s_add_u32 m0, s65, 79872
    s_add_u32 s59, s64, 8396800
    buffer_load_dwordx4 v50, s[40:43], s59 offen offset:0 sc1 lds
    v_mul_f32 v238, v186, v186
    v_mul_f32 v239, v187, v187
    v_fma_f32 v236, v236, v71, v69
    v_fma_f32 v237, v237, v71, v69
    s_waitcnt lgkmcnt(4)
    v_mfma_f32_32x32x16_bf16 v[188:203], a[232:235], v[212:215], v[188:203]
    v_fma_f32 v238, v238, v71, v69
    v_fma_f32 v239, v239, v71, v69
    v_mul_f32 v236, v236, v184
    v_mul_f32 v237, v237, v185
    v_mul_f32 v238, v238, v186
    v_mul_f32 v239, v239, v187
    v_mfma_f32_32x32x16_bf16 v[188:203], a[236:239], v[216:219], v[188:203]
    buffer_load_dwordx4 v50, s[40:43], s59 offen offset:1024 sc1 lds
    v_exp_f32 v236, v236
    v_exp_f32 v237, v237
    s_load_dword s12, s[20:21], 196608 glc
    s_load_dword s13, s[20:21], 196736 glc
    s_waitcnt lgkmcnt(2)
    v_mfma_f32_32x32x16_bf16 v[188:203], a[240:243], v[220:223], v[188:203]
    v_exp_f32 v238, v238
    v_exp_f32 v239, v239
    v_fma_f32 v236, v236, v73, v73
    v_fma_f32 v237, v237, v73, v73
    v_fma_f32 v238, v238, v73, v73
    v_mfma_f32_32x32x16_bf16 v[188:203], a[244:247], v[224:227], v[188:203]
    buffer_load_dwordx4 v50, s[40:43], s59 offen offset:2048 sc1 lds
    v_fma_f32 v239, v239, v73, v73
    v_rcp_f32 v236, v236
    s_waitcnt lgkmcnt(0)
    v_mfma_f32_32x32x16_bf16 v[188:203], a[248:251], v[228:231], v[188:203]
    v_rcp_f32 v237, v237
    v_rcp_f32 v238, v238
    v_rcp_f32 v239, v239
    v_mul_f32 v184, v184, v236
    v_mul_f32 v185, v185, v237
    v_mfma_f32_32x32x16_bf16 v[188:203], a[252:255], v[232:235], v[188:203]
    buffer_load_dwordx4 v50, s[40:43], s59 offen offset:3072 sc1 lds
    v_mul_f32 v186, v186, v238
    v_mul_f32 v187, v187, v239
    v_cvt_pk_bf16_f32 v246, v184, v185
    v_cvt_pk_bf16_f32 v247, v186, v187
    buffer_store_dwordx4 v[240:243], v2, s[40:43], s7 offen offset:0 sc1
    buffer_store_dwordx4 v[244:247], v2, s[40:43], s7 offen offset:1024 sc1
    s_nop 4
    v_pk_mul_f32 v[204:205], v[188:189], v[188:189]
    v_pk_mul_f32 v[206:207], v[190:191], v[190:191]
    v_pk_mul_f32 v[208:209], v[192:193], v[192:193]
    v_pk_mul_f32 v[210:211], v[194:195], v[194:195]
    v_pk_fma_f32 v[204:205], v[204:205], v[70:71], v[68:69] op_sel_hi:[1,0,0]
    v_pk_fma_f32 v[206:207], v[206:207], v[70:71], v[68:69] op_sel_hi:[1,0,0]
    v_pk_fma_f32 v[208:209], v[208:209], v[70:71], v[68:69] op_sel_hi:[1,0,0]
    v_pk_fma_f32 v[210:211], v[210:211], v[70:71], v[68:69] op_sel_hi:[1,0,0]
    v_pk_mul_f32 v[204:205], v[204:205], v[188:189]
    v_pk_mul_f32 v[206:207], v[206:207], v[190:191]
    v_pk_mul_f32 v[208:209], v[208:209], v[192:193]
    v_pk_mul_f32 v[210:211], v[210:211], v[194:195]
    v_exp_f32 v204, v204
    v_exp_f32 v206, v206
    v_exp_f32 v208, v208
    v_exp_f32 v210, v210
    v_exp_f32 v205, v205
    v_exp_f32 v207, v207
    v_exp_f32 v209, v209
    v_exp_f32 v211, v211
    v_pk_fma_f32 v[204:205], v[204:205], v[72:73], v[72:73] op_sel_hi:[1,0,0]
    v_pk_fma_f32 v[206:207], v[206:207], v[72:73], v[72:73] op_sel_hi:[1,0,0]
    v_pk_fma_f32 v[208:209], v[208:209], v[72:73], v[72:73] op_sel_hi:[1,0,0]
    v_pk_fma_f32 v[210:211], v[210:211], v[72:73], v[72:73] op_sel_hi:[1,0,0]
    v_rcp_f32 v204, v204
    v_rcp_f32 v206, v206
    v_rcp_f32 v208, v208
    v_rcp_f32 v210, v210
    v_rcp_f32 v205, v205
    v_rcp_f32 v207, v207
    v_rcp_f32 v209, v209
    v_rcp_f32 v211, v211
    v_pk_mul_f32 v[188:189], v[188:189], v[204:205]
    v_pk_mul_f32 v[190:191], v[190:191], v[206:207]
    v_pk_mul_f32 v[192:193], v[192:193], v[208:209]
    v_pk_mul_f32 v[194:195], v[194:195], v[210:211]
    v_cvt_pk_bf16_f32 v240, v188, v189
    v_cvt_pk_bf16_f32 v241, v190, v191
    v_cvt_pk_bf16_f32 v242, v192, v193
    v_cvt_pk_bf16_f32 v243, v194, v195
    v_pk_mul_f32 v[212:213], v[196:197], v[196:197]
    v_pk_mul_f32 v[214:215], v[198:199], v[198:199]
    v_pk_mul_f32 v[216:217], v[200:201], v[200:201]
    v_pk_mul_f32 v[218:219], v[202:203], v[202:203]
    v_pk_fma_f32 v[212:213], v[212:213], v[70:71], v[68:69] op_sel_hi:[1,0,0]
    v_pk_fma_f32 v[214:215], v[214:215], v[70:71], v[68:69] op_sel_hi:[1,0,0]
    v_pk_fma_f32 v[216:217], v[216:217], v[70:71], v[68:69] op_sel_hi:[1,0,0]
    v_pk_fma_f32 v[218:219], v[218:219], v[70:71], v[68:69] op_sel_hi:[1,0,0]
    v_pk_mul_f32 v[212:213], v[212:213], v[196:197]
    v_pk_mul_f32 v[214:215], v[214:215], v[198:199]
    v_pk_mul_f32 v[216:217], v[216:217], v[200:201]
    v_pk_mul_f32 v[218:219], v[218:219], v[202:203]
    v_exp_f32 v212, v212
    v_exp_f32 v214, v214
    v_exp_f32 v216, v216
    v_exp_f32 v218, v218
    v_exp_f32 v213, v213
    v_exp_f32 v215, v215
    v_exp_f32 v217, v217
    v_exp_f32 v219, v219
    v_pk_fma_f32 v[212:213], v[212:213], v[72:73], v[72:73] op_sel_hi:[1,0,0]
    v_pk_fma_f32 v[214:215], v[214:215], v[72:73], v[72:73] op_sel_hi:[1,0,0]
    v_pk_fma_f32 v[216:217], v[216:217], v[72:73], v[72:73] op_sel_hi:[1,0,0]
    v_pk_fma_f32 v[218:219], v[218:219], v[72:73], v[72:73] op_sel_hi:[1,0,0]
    v_rcp_f32 v212, v212
    v_rcp_f32 v214, v214
    v_rcp_f32 v216, v216
    v_rcp_f32 v218, v218
    v_rcp_f32 v213, v213
    v_rcp_f32 v215, v215
    v_rcp_f32 v217, v217
    v_rcp_f32 v219, v219
    v_pk_mul_f32 v[196:197], v[196:197], v[212:213]
    v_pk_mul_f32 v[198:199], v[198:199], v[214:215]
    v_pk_mul_f32 v[200:201], v[200:201], v[216:217]
    v_pk_mul_f32 v[202:203], v[202:203], v[218:219]
    v_cvt_pk_bf16_f32 v244, v196, v197
    v_cvt_pk_bf16_f32 v245, v198, v199
    v_cvt_pk_bf16_f32 v246, v200, v201
    v_cvt_pk_bf16_f32 v247, v202, v203
    buffer_store_dwordx4 v[240:243], v2, s[40:43], s7 offen offset:2048 sc1
    buffer_store_dwordx4 v[244:247], v2, s[40:43], s7 offen offset:3072 sc1
    s_mov_b32 s56, 0
    s_xor_b64 s[12:13], s[12:13], s[10:11]
    s_cbranch_scc0 Ldone_37
Lpoll_36:
    s_sleep 4
    s_load_dword s12, s[20:21], 196608 glc
    s_load_dword s13, s[20:21], 196736 glc
    s_add_u32 s56, s56, 1
    s_cmp_gt_u32 s56, 0x40000
    s_cbranch_scc1 Ldone_37
    s_waitcnt lgkmcnt(0)
    s_xor_b64 s[12:13], s[12:13], s[10:11]
    s_cbranch_scc0 Ldone_37
    s_branch Lpoll_36
Ldone_37:
    s_barrier
    s_add_u32 m0, s65, 83968
    s_add_u32 s59, s64, 8400896
    buffer_load_dwordx4 v50, s[40:43], s59 offen offset:0 sc1 lds
    buffer_load_dwordx4 v50, s[40:43], s59 offen offset:1024 sc1 lds
    buffer_load_dwordx4 v50, s[40:43], s59 offen offset:2048 sc1 lds
    buffer_load_dwordx4 v50, s[40:43], s59 offen offset:3072 sc1 lds
    s_add_u32 s53, s24, 0
    buffer_load_dwordx4 a[128:131], v51, s[40:43], s53 offen sc1
    s_lshl_b32 s52, s50, 6
    s_add_u32 s52, s52, 1
    v_lshl_add_u32 v245, v3, 1, s52
    v_cvt_f32_u32 v245, v245
    s_lshl_b32 s52, s49, 6
    v_add_u32 v244, s52, v10
    v_cvt_f32_u32 v244, v244
    v_mul_f32 v244, 0x3b000000, v244
    v_mul_f32 v246, 0x41000000, v244
    v_mul_f32 v247, v245, v244
    v_add_f32 v12, v247, v246
    v_cos_f32 v246, v246
    s_add_u32 s53, s24, 4096
    buffer_load_dwordx4 a[132:135], v51, s[40:43], s53 offen sc1
    v_cos_f32 v236, v247
    v_sin_f32_e64 v237, -v247
    v_add_f32 v247, v247, v244
    v_cos_f32 v238, v12
    v_sin_f32_e64 v239, -v12
    v_add_f32 v12, v12, v244
    v_cos_f32 v240, v247
    v_sin_f32_e64 v241, -v247
    s_add_u32 s53, s24, 8192
    buffer_load_dwordx4 a[136:139], v51, s[40:43], s53 offen sc1
    v_add_f32 v246, v246, v246
    v_cos_f32 v242, v12
    v_sin_f32_e64 v243, -v12
    v_cvt_pk_bf16_f32 v172, v236, v237
    v_cvt_pk_bf16_f32 v173, v240, v241
    v_cvt_pk_bf16_f32 v174, v238, v239
    v_pk_fma_f32 v[236:237], v[238:239], v[246:247], v[236:237] op_sel_hi:[1,0,1] neg_lo:[0,0,1] neg_hi:[0,0,1]
    v_cvt_pk_bf16_f32 v175, v242, v243
    v_pk_fma_f32 v[240:241], v[242:243], v[246:247], v[240:241] op_sel_hi:[1,0,1] neg_lo:[0,0,1] neg_hi:[0,0,1]
    v_cvt_pk_bf16_f32 v176, v236, v237
    v_pk_fma_f32 v[238:239], v[236:237], v[246:247], v[238:239] op_sel_hi:[1,0,1] neg_lo:[0,0,1] neg_hi:[0,0,1]
    v_cvt_pk_bf16_f32 v177, v240, v241
    s_add_u32 s53, s24, 12288
    buffer_load_dwordx4 a[140:143], v51, s[40:43], s53 offen sc1
    v_pk_fma_f32 v[242:243], v[240:241], v[246:247], v[242:243] op_sel_hi:[1,0,1] neg_lo:[0,0,1] neg_hi:[0,0,1]
    v_cvt_pk_bf16_f32 v178, v238, v239
    v_pk_fma_f32 v[236:237], v[238:239], v[246:247], v[236:237] op_sel_hi:[1,0,1] neg_lo:[0,0,1] neg_hi:[0,0,1]
    v_cvt_pk_bf16_f32 v179, v242, v243
    v_pk_fma_f32 v[240:241], v[242:243], v[246:247], v[240:241] op_sel_hi:[1,0,1] neg_lo:[0,0,1] neg_hi:[0,0,1]
    v_cvt_pk_bf16_f32 v180, v236, v237
    v_pk_fma_f32 v[238:239], v[236:237], v[246:247], v[238:239] op_sel_hi:[1,0,1] neg_lo:[0,0,1] neg_hi:[0,0,1]
    v_cvt_pk_bf16_f32 v181, v240, v241
    v_pk_fma_f32 v[242:243], v[240:241], v[246:247], v[242:243] op_sel_hi:[1,0,1] neg_lo:[0,0,1] neg_hi:[0,0,1]
    v_cvt_pk_bf16_f32 v182, v238, v239
    v_pk_fma_f32 v[236:237], v[238:239], v[246:247], v[236:237] op_sel_hi:[1,0,1] neg_lo:[0,0,1] neg_hi:[0,0,1]
    v_cvt_pk_bf16_f32 v183, v242, v243
    v_pk_fma_f32 v[240:241], v[242:243], v[246:247], v[240:241] op_sel_hi:[1,0,1] neg_lo:[0,0,1] neg_hi:[0,0,1]
    v_cvt_pk_bf16_f32 v184, v236, v237
    s_add_u32 s53, s24, 28672
    buffer_load_dwordx4 a[144:147], v51, s[40:43], s53 offen sc1
    v_pk_fma_f32 v[238:239], v[236:237], v[246:247], v[238:239] op_sel_hi:[1,0,1] neg_lo:[0,0,1] neg_hi:[0,0,1]
    v_cvt_pk_bf16_f32 v185, v240, v241
    v_pk_fma_f32 v[242:243], v[240:241], v[246:247], v[242:243] op_sel_hi:[1,0,1] neg_lo:[0,0,1] neg_hi:[0,0,1]
    v_cvt_pk_bf16_f32 v186, v238, v239
    v_cvt_pk_bf16_f32 v187, v242, v243
    v_add_f32 v244, 0x3d000000, v244
    v_mul_f32 v246, 0x41000000, v244
    v_mul_f32 v247, v245, v244
    v_add_f32 v12, v247, v246
    v_cos_f32 v246, v246
    v_cos_f32 v236, v247
    s_add_u32 s53, s24, 32768
    buffer_load_dwordx4 a[148:151], v51, s[40:43], s53 offen sc1
    v_sin_f32_e64 v237, -v247
    v_add_f32 v247, v247, v244
    v_cos_f32 v238, v12
    v_sin_f32_e64 v239, -v12
    v_add_f32 v12, v12, v244
    v_cos_f32 v240, v247
    v_sin_f32_e64 v241, -v247
    v_add_f32 v246, v246, v246
    s_add_u32 s53, s24, 36864
    buffer_load_dwordx4 a[152:155], v51, s[40:43], s53 offen sc1
    v_cos_f32 v242, v12
    v_sin_f32_e64 v243, -v12
    v_cvt_pk_bf16_f32 v188, v236, v237
    v_cvt_pk_bf16_f32 v189, v240, v241
    v_cvt_pk_bf16_f32 v190, v238, v239
    v_pk_fma_f32 v[236:237], v[238:239], v[246:247], v[236:237] op_sel_hi:[1,0,1] neg_lo:[0,0,1] neg_hi:[0,0,1]
    v_cvt_pk_bf16_f32 v191, v242, v243
    v_pk_fma_f32 v[240:241], v[242:243], v[246:247], v[240:241] op_sel_hi:[1,0,1] neg_lo:[0,0,1] neg_hi:[0,0,1]
    v_cvt_pk_bf16_f32 v192, v236, v237
    v_pk_fma_f32 v[238:239], v[236:237], v[246:247], v[238:239] op_sel_hi:[1,0,1] neg_lo:[0,0,1] neg_hi:[0,0,1]
    v_cvt_pk_bf16_f32 v193, v240, v241
    v_pk_fma_f32 v[242:243], v[240:241], v[246:247], v[242:243] op_sel_hi:[1,0,1] neg_lo:[0,0,1] neg_hi:[0,0,1]
    s_add_u32 s53, s24, 40960
    buffer_load_dwordx4 a[156:159], v51, s[40:43], s53 offen sc1
    v_cvt_pk_bf16_f32 v194, v238, v239
    v_pk_fma_f32 v[236:237], v[238:239], v[246:247], v[236:237] op_sel_hi:[1,0,1] neg_lo:[0,0,1] neg_hi:[0,0,1]
    v_cvt_pk_bf16_f32 v195, v242, v243
    v_pk_fma_f32 v[240:241], v[242:243], v[246:247], v[240:241] op_sel_hi:[1,0,1] neg_lo:[0,0,1] neg_hi:[0,0,1]
    v_cvt_pk_bf16_f32 v196, v236, v237
    v_pk_fma_f32 v[238:239], v[236:237], v[246:247], v[238:239] op_sel_hi:[1,0,1] neg_lo:[0,0,1] neg_hi:[0,0,1]
    v_cvt_pk_bf16_f32 v197, v240, v241
    v_pk_fma_f32 v[242:243], v[240:241], v[246:247], v[242:243] op_sel_hi:[1,0,1] neg_lo:[0,0,1] neg_hi:[0,0,1]
    v_cvt_pk_bf16_f32 v198, v238, v239
    v_pk_fma_f32 v[236:237], v[238:239], v[246:247], v[236:237] op_sel_hi:[1,0,1] neg_lo:[0,0,1] neg_hi:[0,0,1]
    v_cvt_pk_bf16_f32 v199, v242, v243
    v_pk_fma_f32 v[240:241], v[242:243], v[246:247], v[240:241] op_sel_hi:[1,0,1] neg_lo:[0,0,1] neg_hi:[0,0,1]
    v_cvt_pk_bf16_f32 v200, v236, v237
    v_pk_fma_f32 v[238:239], v[236:237], v[246:247], v[238:239] op_sel_hi:[1,0,1] neg_lo:[0,0,1] neg_hi:[0,0,1]
    s_add_u32 s53, s25, 0
    buffer_load_dwordx4 a[160:163], v51, s[40:43], s53 offen sc1
    v_cvt_pk_bf16_f32 v201, v240, v241
    v_pk_fma_f32 v[242:243], v[240:241], v[246:247], v[242:243] op_sel_hi:[1,0,1] neg_lo:[0,0,1] neg_hi:[0,0,1]
    v_cvt_pk_bf16_f32 v202, v238, v239
    v_cvt_pk_bf16_f32 v203, v242, v243
    v_add_f32 v244, 0x3d000000, v244
    v_mul_f32 v246, 0x41000000, v244
    v_mul_f32 v247, v245, v244
    v_add_f32 v12, v247, v246
    v_cos_f32 v246, v246
    v_cos_f32 v236, v247
    v_sin_f32_e64 v237, -v247
    s_add_u32 s53, s25, 4096
    buffer_load_dwordx4 a[164:167], v51, s[40:43], s53 offen sc1
    v_add_f32 v247, v247, v244
    v_cos_f32 v238, v12
    v_sin_f32_e64 v239, -v12
    v_add_f32 v12, v12, v244
    v_cos_f32 v240, v247
    v_sin_f32_e64 v241, -v247
    v_add_f32 v246, v246, v246
    v_cos_f32 v242, v12
    s_add_u32 s53, s25, 8192
    buffer_load_dwordx4 a[168:171], v51, s[40:43], s53 offen sc1
    v_sin_f32_e64 v243, -v12
    v_cvt_pk_bf16_f32 v204, v236, v237
    v_cvt_pk_bf16_f32 v205, v240, v241
    v_cvt_pk_bf16_f32 v206, v238, v239
    v_pk_fma_f32 v[236:237], v[238:239], v[246:247], v[236:237] op_sel_hi:[1,0,1] neg_lo:[0,0,1] neg_hi:[0,0,1]
    v_cvt_pk_bf16_f32 v207, v242, v243
    v_pk_fma_f32 v[240:241], v[242:243], v[246:247], v[240:241] op_sel_hi:[1,0,1] neg_lo:[0,0,1] neg_hi:[0,0,1]
    v_cvt_pk_bf16_f32 v208, v236, v237
    v_pk_fma_f32 v[238:239], v[236:237], v[246:247], v[238:239] op_sel_hi:[1,0,1] neg_lo:[0,0,1] neg_hi:[0,0,1]
    v_cvt_pk_bf16_f32 v209, v240, v241
    v_pk_fma_f32 v[242:243], v[240:241], v[246:247], v[242:243] op_sel_hi:[1,0,1] neg_lo:[0,0,1] neg_hi:[0,0,1]
    v_cvt_pk_bf16_f32 v210, v238, v239
    v_pk_fma_f32 v[236:237], v[238:239], v[246:247], v[236:237] op_sel_hi:[1,0,1] neg_lo:[0,0,1] neg_hi:[0,0,1]
    s_add_u32 s53, s25, 12288
    buffer_load_dwordx4 a[172:175], v51, s[40:43], s53 offen sc1
    v_cvt_pk_bf16_f32 v211, v242, v243
    v_pk_fma_f32 v[240:241], v[242:243], v[246:247], v[240:241] op_sel_hi:[1,0,1] neg_lo:[0,0,1] neg_hi:[0,0,1]
    v_cvt_pk_bf16_f32 v212, v236, v237
    v_pk_fma_f32 v[238:239], v[236:237], v[246:247], v[238:239] op_sel_hi:[1,0,1] neg_lo:[0,0,1] neg_hi:[0,0,1]
    v_cvt_pk_bf16_f32 v213, v240, v241
    v_pk_fma_f32 v[242:243], v[240:241], v[246:247], v[242:243] op_sel_hi:[1,0,1] neg_lo:[0,0,1] neg_hi:[0,0,1]
    v_cvt_pk_bf16_f32 v214, v238, v239
    v_pk_fma_f32 v[236:237], v[238:239], v[246:247], v[236:237] op_sel_hi:[1,0,1] neg_lo:[0,0,1] neg_hi:[0,0,1]
    v_cvt_pk_bf16_f32 v215, v242, v243
    v_pk_fma_f32 v[240:241], v[242:243], v[246:247], v[240:241] op_sel_hi:[1,0,1] neg_lo:[0,0,1] neg_hi:[0,0,1]
    v_cvt_pk_bf16_f32 v216, v236, v237
    v_pk_fma_f32 v[238:239], v[236:237], v[246:247], v[238:239] op_sel_hi:[1,0,1] neg_lo:[0,0,1] neg_hi:[0,0,1]
    v_cvt_pk_bf16_f32 v217, v240, v241
    v_pk_fma_f32 v[242:243], v[240:241], v[246:247], v[242:243] op_sel_hi:[1,0,1] neg_lo:[0,0,1] neg_hi:[0,0,1]
    buffer_load_dwordx4 a[40:43], v2, s[40:43], s3 offen offset:2048 sc1
    v_cvt_pk_bf16_f32 v218, v238, v239
    v_cvt_pk_bf16_f32 v219, v242, v243
    s_waitcnt vmcnt(12)
    v_mfma_f32_16x16x32_bf16 a[176:179], v[76:79], a[128:131], 0
    v_add_f32 v244, 0x3d000000, v244
    v_mul_f32 v246, 0x41000000, v244
    v_mul_f32 v247, v245, v244
    v_mfma_f32_16x16x32_bf16 a[180:183], v[80:83], a[128:131], 0
    buffer_load_dwordx4 a[44:47], v2, s[40:43], s3 offen offset:3072 sc1
    v_mfma_f32_16x16x32_bf16 a[184:187], v[84:87], a[128:131], 0
    v_add_f32 v12, v247, v246
    v_cos_f32 v246, v246
    v_mfma_f32_16x16x32_bf16 a[188:191], v[88:91], a[128:131], 0
    s_add_u32 s53, s25, 28672
    buffer_load_dwordx4 a[128:131], v51, s[40:43], s53 offen sc1
    s_waitcnt vmcnt(13)
    v_mfma_f32_16x16x32_bf16 a[176:179], v[92:95], a[132:135], a[176:179]
    v_cos_f32 v236, v247
    v_mfma_f32_16x16x32_bf16 a[180:183], v[96:99], a[132:135], a[180:183]
    s_add_u32 s3, s89, 20480
    buffer_load_dwordx4 a[48:51], v2, s[40:43], s3 offen offset:0 sc1
    v_mfma_f32_16x16x32_bf16 a[184:187], v[100:103], a[132:135], a[184:187]
    v_sin_f32_e64 v237, -v247
    v_add_f32 v247, v247, v244
    v_mfma_f32_16x16x32_bf16 a[188:191], v[104:107], a[132:135], a[188:191]
    s_add_u32 s53, s25, 32768
    buffer_load_dwordx4 a[132:135], v51, s[40:43], s53 offen sc1
    s_barrier
    s_cmp_lg_u32 s50, 0
    s_cbranch_scc1 Lpub_39
    s_mov_b64 exec, 0xffff
    v_mov_b32 v8, s51
    v_lshlrev_b32 v9, 2, v1
    s_add_u32 s95, s92, 18186240
    buffer_store_dword v8, v9, s[40:43], s95 offen sc1
    s_mov_b64 exec, -1
Lpub_39:
    s_waitcnt vmcnt(14)
    v_mfma_f32_16x16x32_bf16 a[176:179], v[108:111], a[136:139], a[176:179]
    v_cos_f32 v238, v12
    v_mfma_f32_16x16x32_bf16 a[180:183], v[112:115], a[136:139], a[180:183]
    buffer_load_dwordx4 a[52:55], v2, s[40:43], s3 offen offset:1024 sc1
    v_mfma_f32_16x16x32_bf16 a[184:187], v[116:119], a[136:139], a[184:187]
    v_sin_f32_e64 v239, -v12
    v_add_f32 v12, v12, v244
    v_mfma_f32_16x16x32_bf16 a[188:191], v[120:123], a[136:139], a[188:191]
    s_add_u32 s53, s25, 36864
    buffer_load_dwordx4 a[136:139], v51, s[40:43], s53 offen sc1
    s_waitcnt vmcnt(15)
    v_mfma_f32_16x16x32_bf16 a[176:179], v[124:127], a[140:143], a[176:179]
    v_cos_f32 v240, v247
    v_mfma_f32_16x16x32_bf16 a[180:183], v[128:131], a[140:143], a[180:183]
    buffer_load_dwordx4 a[56:59], v2, s[40:43], s3 offen offset:2048 sc1
    v_mfma_f32_16x16x32_bf16 a[184:187], v[132:135], a[140:143], a[184:187]
    v_sin_f32_e64 v241, -v247
    v_add_f32 v246, v246, v246
    v_mfma_f32_16x16x32_bf16 a[188:191], v[136:139], a[140:143], a[188:191]
    s_add_u32 s53, s25, 40960
    buffer_load_dwordx4 a[140:143], v51, s[40:43], s53 offen sc1
    s_waitcnt vmcnt(16)
    v_mfma_f32_16x16x32_bf16 a[176:179], v[140:143], a[144:147], a[176:179]
    v_cos_f32 v242, v12
    v_mfma_f32_16x16x32_bf16 a[180:183], v[144:147], a[144:147], a[180:183]
    buffer_load_dwordx4 a[60:63], v2, s[40:43], s3 offen offset:3072 sc1
    v_mfma_f32_16x16x32_bf16 a[184:187], v[148:151], a[144:147], a[184:187]
    v_sin_f32_e64 v243, -v12
    v_cvt_pk_bf16_f32 v220, v236, v237
    v_mfma_f32_16x16x32_bf16 a[188:191], v[152:155], a[144:147], a[188:191]
    s_add_u32 s53, s26, 0
    buffer_load_dwordx4 a[144:147], v51, s[40:43], s53 offen sc1
    s_waitcnt vmcnt(17)
    v_mfma_f32_16x16x32_bf16 a[176:179], v[156:159], a[148:151], a[176:179]
    v_cvt_pk_bf16_f32 v221, v240, v241
    v_cvt_pk_bf16_f32 v222, v238, v239
    v_fma_f32 v236, v238, v246, -v236
    v_mfma_f32_16x16x32_bf16 a[180:183], v[160:163], a[148:151], a[180:183]
    s_add_u32 s3, s89, 24576
    buffer_load_dwordx4 a[64:67], v2, s[40:43], s3 offen offset:0 sc1
    v_mfma_f32_16x16x32_bf16 a[184:187], v[164:167], a[148:151], a[184:187]
    v_fma_f32 v237, v239, v246, -v237
    v_cvt_pk_bf16_f32 v223, v242, v243
    v_fma_f32 v240, v242, v246, -v240
    v_mfma_f32_16x16x32_bf16 a[188:191], v[168:171], a[148:151], a[188:191]
    s_add_u32 s53, s26, 4096
    buffer_load_dwordx4 a[148:151], v51, s[40:43], s53 offen sc1
    s_waitcnt vmcnt(18)
    v_mfma_f32_16x16x32_bf16 a[176:179], a[0:3], a[152:155], a[176:179]
    v_fma_f32 v241, v243, v246, -v241
    v_cvt_pk_bf16_f32 v224, v236, v237
    v_fma_f32 v238, v236, v246, -v238
    v_mfma_f32_16x16x32_bf16 a[180:183], a[4:7], a[152:155], a[180:183]
    buffer_load_dwordx4 a[68:71], v2, s[40:43], s3 offen offset:1024 sc1
    v_mfma_f32_16x16x32_bf16 a[184:187], a[8:11], a[152:155], a[184:187]
    v_fma_f32 v239, v237, v246, -v239
    v_cvt_pk_bf16_f32 v225, v240, v241
    v_fma_f32 v242, v240, v246, -v242
    v_mfma_f32_16x16x32_bf16 a[188:191], a[12:15], a[152:155], a[188:191]
    s_add_u32 s53, s26, 8192
    buffer_load_dwordx4 a[152:155], v51, s[40:43], s53 offen sc1
    s_waitcnt vmcnt(19)
    v_mfma_f32_16x16x32_bf16 a[176:179], a[16:19], a[156:159], a[176:179]
    v_fma_f32 v243, v241, v246, -v243
    v_cvt_pk_bf16_f32 v226, v238, v239
    v_fma_f32 v236, v238, v246, -v236
    v_mfma_f32_16x16x32_bf16 a[180:183], a[20:23], a[156:159], a[180:183]
    buffer_load_dwordx4 a[72:75], v2, s[40:43], s3 offen offset:2048 sc1
    v_mfma_f32_16x16x32_bf16 a[184:187], a[24:27], a[156:159], a[184:187]
    v_fma_f32 v237, v239, v246, -v237
    v_cvt_pk_bf16_f32 v227, v242, v243
    v_fma_f32 v240, v242, v246, -v240
    v_mfma_f32_16x16x32_bf16 a[188:191], a[28:31], a[156:159], a[188:191]
    s_add_u32 s53, s26, 12288
    buffer_load_dwordx4 a[156:159], v51, s[40:43], s53 offen sc1
    s_waitcnt vmcnt(20)
    v_mfma_f32_16x16x32_bf16 a[192:195], v[76:79], a[160:163], 0
    v_fma_f32 v241, v243, v246, -v241
    v_cvt_pk_bf16_f32 v228, v236, v237
    v_fma_f32 v238, v236, v246, -v238
    v_mfma_f32_16x16x32_bf16 a[196:199], v[80:83], a[160:163], 0
    buffer_load_dwordx4 a[76:79], v2, s[40:43], s3 offen offset:3072 sc1
    v_mfma_f32_16x16x32_bf16 a[200:203], v[84:87], a[160:163], 0
    v_fma_f32 v239, v237, v246, -v239
    v_cvt_pk_bf16_f32 v229, v240, v241
    v_fma_f32 v242, v240, v246, -v242
    v_mfma_f32_16x16x32_bf16 a[204:207], v[88:91], a[160:163], 0
    s_add_u32 s53, s26, 28672
    buffer_load_dwordx4 a[160:163], v51, s[40:43], s53 offen sc1
    s_waitcnt vmcnt(21)
    v_mfma_f32_16x16x32_bf16 a[192:195], v[92:95], a[164:167], a[192:195]
    v_fma_f32 v243, v241, v246, -v243
    v_cvt_pk_bf16_f32 v230, v238, v239
    v_fma_f32 v236, v238, v246, -v236
    v_mfma_f32_16x16x32_bf16 a[196:199], v[96:99], a[164:167], a[196:199]
    s_add_u32 s3, s89, 45056
    buffer_load_dwordx4 a[80:83], v2, s[40:43], s3 offen offset:0 sc1
    v_mfma_f32_16x16x32_bf16 a[200:203], v[100:103], a[164:167], a[200:203]
    v_fma_f32 v237, v239, v246, -v237
    v_cvt_pk_bf16_f32 v231, v242, v243
    v_fma_f32 v240, v242, v246, -v240
    v_mfma_f32_16x16x32_bf16 a[204:207], v[104:107], a[164:167], a[204:207]
    s_add_u32 s53, s26, 32768
    buffer_load_dwordx4 a[164:167], v51, s[40:43], s53 offen sc1
    s_waitcnt vmcnt(22)
    v_mfma_f32_16x16x32_bf16 a[192:195], v[108:111], a[168:171], a[192:195]
    v_fma_f32 v241, v243, v246, -v241
    v_cvt_pk_bf16_f32 v232, v236, v237
    v_fma_f32 v238, v236, v246, -v238
    v_mfma_f32_16x16x32_bf16 a[196:199], v[112:115], a[168:171], a[196:199]
    buffer_load_dwordx4 a[84:87], v2, s[40:43], s3 offen offset:1024 sc1
    v_mfma_f32_16x16x32_bf16 a[200:203], v[116:119], a[168:171], a[200:203]
    v_fma_f32 v239, v237, v246, -v239
    v_cvt_pk_bf16_f32 v233, v240, v241
    v_fma_f32 v242, v240, v246, -v242
    v_mfma_f32_16x16x32_bf16 a[204:207], v[120:123], a[168:171], a[204:207]
    s_add_u32 s53, s26, 36864
    buffer_load_dwordx4 a[168:171], v51, s[40:43], s53 offen sc1
    s_waitcnt vmcnt(23)
    v_mfma_f32_16x16x32_bf16 a[192:195], v[124:127], a[172:175], a[192:195]
    v_fma_f32 v243, v241, v246, -v243
    v_cvt_pk_bf16_f32 v234, v238, v239
    v_cvt_pk_bf16_f32 v235, v242, v243
    v_mfma_f32_16x16x32_bf16 a[196:199], v[128:131], a[172:175], a[196:199]
    buffer_load_dwordx4 a[88:91], v2, s[40:43], s3 offen offset:2048 sc1
    v_mfma_f32_16x16x32_bf16 a[200:203], v[132:135], a[172:175], a[200:203]
    v_mfma_f32_16x16x32_bf16 a[204:207], v[136:139], a[172:175], a[204:207]
    s_add_u32 s53, s26, 40960
    buffer_load_dwordx4 a[172:175], v51, s[40:43], s53 offen sc1
    s_load_dword s12, s[20:21], 98304 glc
    s_load_dword s13, s[20:21], 98432 glc
    ds_read_b64_tr_b16 v[236:237], v252 offset:0
    ds_read_b64_tr_b16 v[238:239], v252 offset:2048
    ds_read_b64_tr_b16 v[240:241], v252 offset:4096
    ds_read_b64_tr_b16 v[242:243], v252 offset:6144
    s_waitcnt vmcnt(22)
    v_mfma_f32_16x16x32_bf16 a[192:195], v[140:143], a[128:131], a[192:195]
    v_mfma_f32_16x16x32_bf16 a[196:199], v[144:147], a[128:131], a[196:199]
    buffer_load_dwordx4 a[92:95], v2, s[40:43], s3 offen offset:3072 sc1
    v_mfma_f32_16x16x32_bf16 a[200:203], v[148:151], a[128:131], a[200:203]
    v_mfma_f32_16x16x32_bf16 a[204:207], v[152:155], a[128:131], a[204:207]
    s_add_u32 s53, s27, 0
    buffer_load_dwordx4 a[128:131], v51, s[40:43], s53 offen sc1
    s_waitcnt vmcnt(22)
    v_mfma_f32_16x16x32_bf16 a[192:195], v[156:159], a[132:135], a[192:195]
    v_mfma_f32_16x16x32_bf16 a[196:199], v[160:163], a[132:135], a[196:199]
    s_add_u32 s3, s89, 49152
    buffer_load_dwordx4 a[96:99], v2, s[40:43], s3 offen offset:0 sc1
    v_mfma_f32_16x16x32_bf16 a[200:203], v[164:167], a[132:135], a[200:203]
    v_mfma_f32_16x16x32_bf16 a[204:207], v[168:171], a[132:135], a[204:207]
    s_add_u32 s53, s27, 4096
    buffer_load_dwordx4 a[132:135], v51, s[40:43], s53 offen sc1
    s_waitcnt lgkmcnt(2)
    v_mfma_f32_16x16x32_bf16 a[224:227], v[172:175], v[236:239], 0
    ds_read_b64_tr_b16 v[244:245], v252 offset:8192
    ds_read_b64_tr_b16 v[246:247], v252 offset:10240
    v_mfma_f32_16x16x32_bf16 a[228:231], v[188:191], v[236:239], 0
    v_mfma_f32_16x16x32_bf16 a[232:235], v[204:207], v[236:239], 0
    s_waitcnt vmcnt(22)
    v_mfma_f32_16x16x32_bf16 a[192:195], a[0:3], a[136:139], a[192:195]
    v_mfma_f32_16x16x32_bf16 a[196:199], a[4:7], a[136:139], a[196:199]
    buffer_load_dwordx4 a[100:103], v2, s[40:43], s3 offen offset:1024 sc1
    v_mfma_f32_16x16x32_bf16 a[200:203], a[8:11], a[136:139], a[200:203]
    v_mfma_f32_16x16x32_bf16 a[204:207], a[12:15], a[136:139], a[204:207]
    s_add_u32 s53, s27, 8192
    buffer_load_dwordx4 a[136:139], v51, s[40:43], s53 offen sc1
    v_mfma_f32_16x16x32_bf16 a[236:239], v[220:223], v[236:239], 0
    s_waitcnt lgkmcnt(2)
    v_mfma_f32_16x16x32_bf16 a[224:227], v[176:179], v[240:243], a[224:227]
    ds_read_b64_tr_b16 v[236:237], v252 offset:12288
    ds_read_b64_tr_b16 v[238:239], v252 offset:14336
    v_mfma_f32_16x16x32_bf16 a[228:231], v[192:195], v[240:243], a[228:231]
    s_waitcnt vmcnt(22)
    v_mfma_f32_16x16x32_bf16 a[192:195], a[16:19], a[140:143], a[192:195]
    v_mfma_f32_16x16x32_bf16 a[196:199], a[20:23], a[140:143], a[196:199]
    buffer_load_dwordx4 a[104:107], v2, s[40:43], s3 offen offset:2048 sc1
    v_mfma_f32_16x16x32_bf16 a[200:203], a[24:27], a[140:143], a[200:203]
    v_mfma_f32_16x16x32_bf16 a[204:207], a[28:31], a[140:143], a[204:207]
    s_add_u32 s53, s27, 12288
    buffer_load_dwordx4 a[140:143], v51, s[40:43], s53 offen sc1
    v_mfma_f32_16x16x32_bf16 a[232:235], v[208:211], v[240:243], a[232:235]
    v_mfma_f32_16x16x32_bf16 a[236:239], v[224:227], v[240:243], a[236:239]
    s_waitcnt lgkmcnt(2)
    v_mfma_f32_16x16x32_bf16 a[224:227], v[180:183], v[244:247], a[224:227]
    ds_read_b64_tr_b16 v[240:241], v253 offset:0
    ds_read_b64_tr_b16 v[242:243], v253 offset:2048
    s_waitcnt vmcnt(22)
    v_mfma_f32_16x16x32_bf16 a[208:211], v[76:79], a[144:147], 0
    v_mfma_f32_16x16x32_bf16 a[212:215], v[80:83], a[144:147], 0
    buffer_load_dwordx4 a[108:111], v2, s[40:43], s3 offen offset:3072 sc1
    v_mfma_f32_16x16x32_bf16 a[216:219], v[84:87], a[144:147], 0
    v_mfma_f32_16x16x32_bf16 a[220:223], v[88:91], a[144:147], 0
    s_add_u32 s53, s27, 28672
    buffer_load_dwordx4 a[144:147], v51, s[40:43], s53 offen sc1
    v_mfma_f32_16x16x32_bf16 a[228:231], v[196:199], v[244:247], a[228:231]
    v_mfma_f32_16x16x32_bf16 a[232:235], v[212:215], v[244:247], a[232:235]
    v_mfma_f32_16x16x32_bf16 a[236:239], v[228:231], v[244:247], a[236:239]
    s_waitcnt vmcnt(22)
    v_mfma_f32_16x16x32_bf16 a[208:211], v[92:95], a[148:151], a[208:211]
    v_mfma_f32_16x16x32_bf16 a[212:215], v[96:99], a[148:151], a[212:215]
    s_add_u32 s3, s89, 53248
    buffer_load_dwordx4 a[112:115], v2, s[40:43], s3 offen offset:0 sc1
    v_mfma_f32_16x16x32_bf16 a[216:219], v[100:103], a[148:151], a[216:219]
    v_mfma_f32_16x16x32_bf16 a[220:223], v[104:107], a[148:151], a[220:223]
    s_add_u32 s53, s27, 32768
    buffer_load_dwordx4 a[148:151], v51, s[40:43], s53 offen sc1
    s_waitcnt lgkmcnt(2)
    v_mfma_f32_16x16x32_bf16 a[224:227], v[184:187], v[236:239], a[224:227]
    ds_read_b64_tr_b16 v[244:245], v253 offset:4096
    ds_read_b64_tr_b16 v[246:247], v253 offset:6144
    v_mfma_f32_16x16x32_bf16 a[228:231], v[200:203], v[236:239], a[228:231]
    v_mfma_f32_16x16x32_bf16 a[232:235], v[216:219], v[236:239], a[232:235]
    s_waitcnt vmcnt(22)
    v_mfma_f32_16x16x32_bf16 a[208:211], v[108:111], a[152:155], a[208:211]
    v_mfma_f32_16x16x32_bf16 a[212:215], v[112:115], a[152:155], a[212:215]
    buffer_load_dwordx4 a[116:119], v2, s[40:43], s3 offen offset:1024 sc1
    v_mfma_f32_16x16x32_bf16 a[216:219], v[116:119], a[152:155], a[216:219]
    v_mfma_f32_16x16x32_bf16 a[220:223], v[120:123], a[152:155], a[220:223]
    s_add_u32 s53, s27, 36864
    buffer_load_dwordx4 a[152:155], v51, s[40:43], s53 offen sc1
    v_mfma_f32_16x16x32_bf16 a[236:239], v[232:235], v[236:239], a[236:239]
    s_waitcnt lgkmcnt(2)
    v_mfma_f32_16x16x32_bf16 a[240:243], v[172:175], v[240:243], 0
    ds_read_b64_tr_b16 v[236:237], v253 offset:8192
    ds_read_b64_tr_b16 v[238:239], v253 offset:10240
    v_mfma_f32_16x16x32_bf16 a[244:247], v[188:191], v[240:243], 0
    s_waitcnt vmcnt(22)
    v_mfma_f32_16x16x32_bf16 a[208:211], v[124:127], a[156:159], a[208:211]
    ds_write_b128 v49, a[224:227] offset:0
    v_mfma_f32_16x16x32_bf16 a[212:215], v[128:131], a[156:159], a[212:215]
    buffer_load_dwordx4 a[120:123], v2, s[40:43], s3 offen offset:2048 sc1
    v_mfma_f32_16x16x32_bf16 a[216:219], v[132:135], a[156:159], a[216:219]
    v_mfma_f32_16x16x32_bf16 a[220:223], v[136:139], a[156:159], a[220:223]
    s_add_u32 s53, s27, 40960
    buffer_load_dwordx4 a[156:159], v51, s[40:43], s53 offen sc1
    v_mfma_f32_16x16x32_bf16 a[248:251], v[204:207], v[240:243], 0
    v_mfma_f32_16x16x32_bf16 a[252:255], v[220:223], v[240:243], 0
    s_waitcnt lgkmcnt(3)
    v_mfma_f32_16x16x32_bf16 a[240:243], v[176:179], v[244:247], a[240:243]
    ds_read_b64_tr_b16 v[240:241], v253 offset:12288
    ds_read_b64_tr_b16 v[242:243], v253 offset:14336
    s_mov_b32 s56, 0
    s_waitcnt lgkmcnt(0)
    s_xor_b64 s[12:13], s[12:13], s[10:11]
    s_cbranch_scc0 Ldone_42
Lpoll_41:
    s_sleep 4
    s_load_dword s12, s[20:21], 98304 glc
    s_load_dword s13, s[20:21], 98432 glc
    s_add_u32 s56, s56, 1
    s_cmp_gt_u32 s56, 0x40000
    s_cbranch_scc1 Ldone_42
    s_waitcnt lgkmcnt(0)
    s_xor_b64 s[12:13], s[12:13], s[10:11]
    s_cbranch_scc0 Ldone_42
    s_branch Lpoll_41
Ldone_42:
    s_barrier
    s_waitcnt vmcnt(22)
    v_mfma_f32_16x16x32_bf16 a[208:211], v[140:143], a[160:163], a[208:211]
    ds_write_b128 v49, a[228:231] offset:1024
    v_mfma_f32_16x16x32_bf16 a[212:215], v[144:147], a[160:163], a[212:215]
    buffer_load_dwordx4 a[124:127], v2, s[40:43], s3 offen offset:3072 sc1
    v_mfma_f32_16x16x32_bf16 a[216:219], v[148:151], a[160:163], a[216:219]
    v_mfma_f32_16x16x32_bf16 a[220:223], v[152:155], a[160:163], a[220:223]
    s_add_u32 s53, s24, 16384
    buffer_load_dwordx4 a[160:163], v51, s[40:43], s53 offen sc1
    v_mfma_f32_16x16x32_bf16 a[244:247], v[192:195], v[244:247], a[244:247]
    v_mfma_f32_16x16x32_bf16 a[248:251], v[208:211], v[244:247], a[248:251]
    v_mfma_f32_16x16x32_bf16 a[252:255], v[224:227], v[244:247], a[252:255]
    s_waitcnt vmcnt(22)
    v_mfma_f32_16x16x32_bf16 a[208:211], v[156:159], a[164:167], a[208:211]
    ds_write_b128 v49, a[232:235] offset:2048
    v_mfma_f32_16x16x32_bf16 a[212:215], v[160:163], a[164:167], a[212:215]
    v_mfma_f32_16x16x32_bf16 a[216:219], v[164:167], a[164:167], a[216:219]
    v_mfma_f32_16x16x32_bf16 a[220:223], v[168:171], a[164:167], a[220:223]
    s_add_u32 s53, s24, 20480
    buffer_load_dwordx4 a[164:167], v51, s[40:43], s53 offen sc1
    v_mfma_f32_16x16x32_bf16 a[240:243], v[180:183], v[236:239], a[240:243]
    ds_read_b64_tr_b16 v[244:245], v254 offset:0
    ds_read_b64_tr_b16 v[246:247], v254 offset:2048
    v_mfma_f32_16x16x32_bf16 a[244:247], v[196:199], v[236:239], a[244:247]
    v_mfma_f32_16x16x32_bf16 a[248:251], v[212:215], v[236:239], a[248:251]
    s_waitcnt vmcnt(21)
    v_mfma_f32_16x16x32_bf16 a[208:211], a[0:3], a[168:171], a[208:211]
    ds_write_b128 v49, a[236:239] offset:3072
    v_mfma_f32_16x16x32_bf16 a[212:215], a[4:7], a[168:171], a[212:215]
    v_mfma_f32_16x16x32_bf16 a[216:219], a[8:11], a[168:171], a[216:219]
    v_mfma_f32_16x16x32_bf16 a[220:223], a[12:15], a[168:171], a[220:223]
    s_add_u32 s53, s24, 24576
    buffer_load_dwordx4 a[168:171], v51, s[40:43], s53 offen sc1
    v_mfma_f32_16x16x32_bf16 a[252:255], v[228:231], v[236:239], a[252:255]
    v_mfma_f32_16x16x32_bf16 a[240:243], v[184:187], v[240:243], a[240:243]
    ds_read_b64_tr_b16 v[236:237], v254 offset:4096
    ds_read_b64_tr_b16 v[238:239], v254 offset:6144
    v_mfma_f32_16x16x32_bf16 a[244:247], v[200:203], v[240:243], a[244:247]
    s_waitcnt vmcnt(20)
    v_mfma_f32_16x16x32_bf16 a[208:211], a[16:19], a[172:175], a[208:211]
    v_mfma_f32_16x16x32_bf16 a[212:215], a[20:23], a[172:175], a[212:215]
    v_mfma_f32_16x16x32_bf16 a[216:219], a[24:27], a[172:175], a[216:219]
    v_mfma_f32_16x16x32_bf16 a[220:223], a[28:31], a[172:175], a[220:223]
    s_add_u32 s53, s24, 45056
    buffer_load_dwordx4 a[172:175], v51, s[40:43], s53 offen sc1
    v_mfma_f32_16x16x32_bf16 a[248:251], v[216:219], v[240:243], a[248:251]
    v_mfma_f32_16x16x32_bf16 a[252:255], v[232:235], v[240:243], a[252:255]
    s_waitcnt lgkmcnt(3)
    v_mfma_f32_16x16x32_bf16 a[224:227], v[172:175], v[244:247], 0
    ds_read_b64_tr_b16 v[240:241], v254 offset:8192
    ds_read_b64_tr_b16 v[242:243], v254 offset:10240
    s_waitcnt vmcnt(19)
    v_mfma_f32_16x16x32_bf16 v[28:31], v[76:79], a[128:131], v[28:31]
    ds_write_b128 v49, a[240:243] offset:4096
    v_mfma_f32_16x16x32_bf16 v[32:35], v[80:83], a[128:131], v[32:35]
    v_mfma_f32_16x16x32_bf16 v[36:39], v[84:87], a[128:131], v[36:39]
    v_mfma_f32_16x16x32_bf16 v[40:43], v[88:91], a[128:131], v[40:43]
    s_add_u32 s53, s24, 49152
    buffer_load_dwordx4 a[128:131], v51, s[40:43], s53 offen sc1
    v_mfma_f32_16x16x32_bf16 a[228:231], v[188:191], v[244:247], 0
    v_mfma_f32_16x16x32_bf16 a[232:235], v[204:207], v[244:247], 0
    v_mfma_f32_16x16x32_bf16 a[236:239], v[220:223], v[244:247], 0
    s_waitcnt vmcnt(18)
    v_mfma_f32_16x16x32_bf16 v[28:31], v[92:95], a[132:135], v[28:31]
    ds_write_b128 v49, a[244:247] offset:5120
    v_mfma_f32_16x16x32_bf16 v[32:35], v[96:99], a[132:135], v[32:35]
    v_mfma_f32_16x16x32_bf16 v[36:39], v[100:103], a[132:135], v[36:39]
    v_mfma_f32_16x16x32_bf16 v[40:43], v[104:107], a[132:135], v[40:43]
    s_add_u32 s53, s24, 53248
    buffer_load_dwordx4 a[132:135], v51, s[40:43], s53 offen sc1
    s_waitcnt lgkmcnt(4)
    v_mfma_f32_16x16x32_bf16 a[224:227], v[176:179], v[236:239], a[224:227]
    ds_read_b64_tr_b16 v[244:245], v254 offset:12288
    ds_read_b64_tr_b16 v[246:247], v254 offset:14336
    v_mfma_f32_16x16x32_bf16 a[228:231], v[192:195], v[236:239], a[228:231]
    v_mfma_f32_16x16x32_bf16 a[232:235], v[208:211], v[236:239], a[232:235]
    s_waitcnt vmcnt(17)
    v_mfma_f32_16x16x32_bf16 v[28:31], v[108:111], a[136:139], v[28:31]
    ds_write_b128 v49, a[248:251] offset:6144
    v_mfma_f32_16x16x32_bf16 v[32:35], v[112:115], a[136:139], v[32:35]
    v_mfma_f32_16x16x32_bf16 v[36:39], v[116:119], a[136:139], v[36:39]
    v_mfma_f32_16x16x32_bf16 v[40:43], v[120:123], a[136:139], v[40:43]
    s_add_u32 s53, s25, 16384
    buffer_load_dwordx4 a[136:139], v51, s[40:43], s53 offen sc1
    v_mfma_f32_16x16x32_bf16 a[236:239], v[224:227], v[236:239], a[236:239]
    s_waitcnt lgkmcnt(5)
    v_mfma_f32_16x16x32_bf16 a[224:227], v[180:183], v[240:243], a[224:227]
    ds_read_b64_tr_b16 v[236:237], v255 offset:0
    ds_read_b64_tr_b16 v[238:239], v255 offset:2048
    v_mfma_f32_16x16x32_bf16 a[228:231], v[196:199], v[240:243], a[228:231]
    s_waitcnt vmcnt(16)
    v_mfma_f32_16x16x32_bf16 v[28:31], v[124:127], a[140:143], v[28:31]
    ds_write_b128 v49, a[252:255] offset:7168
    v_mfma_f32_16x16x32_bf16 v[32:35], v[128:131], a[140:143], v[32:35]
    v_mfma_f32_16x16x32_bf16 v[36:39], v[132:135], a[140:143], v[36:39]
    v_mfma_f32_16x16x32_bf16 v[40:43], v[136:139], a[140:143], v[40:43]
    s_add_u32 s53, s25, 20480
    buffer_load_dwordx4 a[140:143], v51, s[40:43], s53 offen sc1
    v_mfma_f32_16x16x32_bf16 a[232:235], v[212:215], v[240:243], a[232:235]
    v_mfma_f32_16x16x32_bf16 a[236:239], v[228:231], v[240:243], a[236:239]
    s_waitcnt lgkmcnt(4)
    v_mfma_f32_16x16x32_bf16 a[224:227], v[184:187], v[244:247], a[224:227]
    ds_read_b64_tr_b16 v[240:241], v255 offset:4096
    ds_read_b64_tr_b16 v[242:243], v255 offset:6144
    s_waitcnt vmcnt(15)
    v_mfma_f32_16x16x32_bf16 v[28:31], v[140:143], a[144:147], v[28:31]
    v_mfma_f32_16x16x32_bf16 v[32:35], v[144:147], a[144:147], v[32:35]
    v_mfma_f32_16x16x32_bf16 v[36:39], v[148:151], a[144:147], v[36:39]
    v_mfma_f32_16x16x32_bf16 v[40:43], v[152:155], a[144:147], v[40:43]
    s_add_u32 s53, s25, 24576
    buffer_load_dwordx4 a[144:147], v51, s[40:43], s53 offen sc1
    v_mfma_f32_16x16x32_bf16 a[228:231], v[200:203], v[244:247], a[228:231]
    v_mfma_f32_16x16x32_bf16 a[232:235], v[216:219], v[244:247], a[232:235]
    v_mfma_f32_16x16x32_bf16 a[236:239], v[232:235], v[244:247], a[236:239]
    s_waitcnt vmcnt(14)
    v_mfma_f32_16x16x32_bf16 v[28:31], v[156:159], a[148:151], v[28:31]
    ds_write_b128 v49, a[224:227] offset:8192
    v_mfma_f32_16x16x32_bf16 v[32:35], v[160:163], a[148:151], v[32:35]
    v_mfma_f32_16x16x32_bf16 v[36:39], v[164:167], a[148:151], v[36:39]
    v_mfma_f32_16x16x32_bf16 v[40:43], v[168:171], a[148:151], v[40:43]
    s_add_u32 s53, s25, 45056
    buffer_load_dwordx4 a[148:151], v51, s[40:43], s53 offen sc1
    s_waitcnt lgkmcnt(4)
    v_mfma_f32_16x16x32_bf16 v[60:63], v[172:175], v[236:239], 0
    ds_read_b64_tr_b16 v[244:245], v255 offset:8192
    ds_read_b64_tr_b16 v[246:247], v255 offset:10240
    v_mfma_f32_16x16x32_bf16 v[64:67], v[188:191], v[236:239], 0
    s_waitcnt vmcnt(13)
    v_mfma_f32_16x16x32_bf16 v[28:31], a[0:3], a[152:155], v[28:31]
    ds_write_b128 v49, a[228:231] offset:9216
    v_mfma_f32_16x16x32_bf16 v[32:35], a[4:7], a[152:155], v[32:35]
    v_mfma_f32_16x16x32_bf16 v[36:39], a[8:11], a[152:155], v[36:39]
    v_mfma_f32_16x16x32_bf16 v[40:43], a[12:15], a[152:155], v[40:43]
    s_add_u32 s53, s25, 49152
    buffer_load_dwordx4 a[152:155], v51, s[40:43], s53 offen sc1
    v_mfma_f32_16x16x32_bf16 v[68:71], v[204:207], v[236:239], 0
    v_mfma_f32_16x16x32_bf16 v[72:75], v[220:223], v[236:239], 0
    s_waitcnt vmcnt(12)
    v_mfma_f32_16x16x32_bf16 v[28:31], a[16:19], a[156:159], v[28:31]
    ds_write_b128 v49, a[232:235] offset:10240
    v_mfma_f32_16x16x32_bf16 v[32:35], a[20:23], a[156:159], v[32:35]
    v_mfma_f32_16x16x32_bf16 v[36:39], a[24:27], a[156:159], v[36:39]
    v_mfma_f32_16x16x32_bf16 v[40:43], a[28:31], a[156:159], v[40:43]
    s_add_u32 s53, s25, 53248
    buffer_load_dwordx4 a[156:159], v51, s[40:43], s53 offen sc1
    s_waitcnt lgkmcnt(5)
    v_mfma_f32_16x16x32_bf16 v[60:63], v[176:179], v[240:243], v[60:63]
    ds_read_b64_tr_b16 v[236:237], v255 offset:12288
    ds_read_b64_tr_b16 v[238:239], v255 offset:14336
    v_mfma_f32_16x16x32_bf16 v[64:67], v[192:195], v[240:243], v[64:67]
    s_waitcnt vmcnt(11)
    v_mfma_f32_16x16x32_bf16 a[176:179], a[32:35], a[160:163], a[176:179]
    ds_write_b128 v49, a[236:239] offset:11264
    v_mfma_f32_16x16x32_bf16 a[180:183], a[36:39], a[160:163], a[180:183]
    v_mfma_f32_16x16x32_bf16 a[184:187], a[40:43], a[160:163], a[184:187]
    v_mfma_f32_16x16x32_bf16 a[188:191], a[44:47], a[160:163], a[188:191]
    s_add_u32 s53, s26, 16384
    buffer_load_dwordx4 a[160:163], v51, s[40:43], s53 offen sc1
    v_mfma_f32_16x16x32_bf16 v[68:71], v[208:211], v[240:243], v[68:71]
    v_mfma_f32_16x16x32_bf16 v[72:75], v[224:227], v[240:243], v[72:75]
    s_waitcnt vmcnt(11)
    v_mfma_f32_16x16x32_bf16 a[176:179], a[48:51], a[164:167], a[176:179]
    v_mfma_f32_16x16x32_bf16 a[180:183], a[52:55], a[164:167], a[180:183]
    v_mfma_f32_16x16x32_bf16 a[184:187], a[56:59], a[164:167], a[184:187]
    v_mfma_f32_16x16x32_bf16 a[188:191], a[60:63], a[164:167], a[188:191]
    s_add_u32 s53, s26, 20480
    buffer_load_dwordx4 a[164:167], v51, s[40:43], s53 offen sc1
    s_waitcnt lgkmcnt(5)
    v_mfma_f32_16x16x32_bf16 v[60:63], v[180:183], v[244:247], v[60:63]
    v_mfma_f32_16x16x32_bf16 v[64:67], v[196:199], v[244:247], v[64:67]
    s_waitcnt vmcnt(11)
    v_mfma_f32_16x16x32_bf16 a[176:179], a[64:67], a[168:171], a[176:179]
    v_mfma_f32_16x16x32_bf16 a[180:183], a[68:71], a[168:171], a[180:183]
    v_mfma_f32_16x16x32_bf16 a[184:187], a[72:75], a[168:171], a[184:187]
    v_mfma_f32_16x16x32_bf16 a[188:191], a[76:79], a[168:171], a[188:191]
    s_add_u32 s53, s26, 24576
    buffer_load_dwordx4 a[168:171], v51, s[40:43], s53 offen sc1
    v_mfma_f32_16x16x32_bf16 v[68:71], v[212:215], v[244:247], v[68:71]
    v_mfma_f32_16x16x32_bf16 v[72:75], v[228:231], v[244:247], v[72:75]
    s_waitcnt vmcnt(11)
    v_mfma_f32_16x16x32_bf16 a[176:179], a[80:83], a[172:175], a[176:179]
    v_mfma_f32_16x16x32_bf16 a[180:183], a[84:87], a[172:175], a[180:183]
    v_mfma_f32_16x16x32_bf16 a[184:187], a[88:91], a[172:175], a[184:187]
    v_mfma_f32_16x16x32_bf16 a[188:191], a[92:95], a[172:175], a[188:191]
    s_add_u32 s53, s26, 45056
    buffer_load_dwordx4 a[172:175], v51, s[40:43], s53 offen sc1
    s_waitcnt lgkmcnt(1)
    v_mfma_f32_16x16x32_bf16 v[60:63], v[184:187], v[236:239], v[60:63]
    v_mfma_f32_16x16x32_bf16 v[64:67], v[200:203], v[236:239], v[64:67]
    s_waitcnt vmcnt(11)
    v_mfma_f32_16x16x32_bf16 a[176:179], a[96:99], a[128:131], a[176:179]
    v_mfma_f32_16x16x32_bf16 a[180:183], a[100:103], a[128:131], a[180:183]
    v_mfma_f32_16x16x32_bf16 a[184:187], a[104:107], a[128:131], a[184:187]
    v_mfma_f32_16x16x32_bf16 a[188:191], a[108:111], a[128:131], a[188:191]
    s_add_u32 s53, s26, 49152
    buffer_load_dwordx4 a[128:131], v51, s[40:43], s53 offen sc1
    v_mfma_f32_16x16x32_bf16 v[68:71], v[216:219], v[236:239], v[68:71]
    v_mfma_f32_16x16x32_bf16 v[72:75], v[232:235], v[236:239], v[72:75]
    s_waitcnt vmcnt(11)
    v_mfma_f32_16x16x32_bf16 a[176:179], a[112:115], a[132:135], a[176:179]
    v_mfma_f32_16x16x32_bf16 a[180:183], a[116:119], a[132:135], a[180:183]
    v_mfma_f32_16x16x32_bf16 a[184:187], a[120:123], a[132:135], a[184:187]
    v_mfma_f32_16x16x32_bf16 a[188:191], a[124:127], a[132:135], a[188:191]
    s_add_u32 s53, s26, 53248
    buffer_load_dwordx4 a[132:135], v51, s[40:43], s53 offen sc1
    s_waitcnt lgkmcnt(0)
    s_barrier
    ds_read_b128 v[172:175], v248 offset:0
    ds_read_b128 v[176:179], v248 offset:1024
    ds_read_b128 v[180:183], v248 offset:2048
    ds_read_b128 v[184:187], v248 offset:3072
    ds_read_b128 v[188:191], v249 offset:0
    ds_read_b128 v[192:195], v249 offset:1024
    ds_read_b128 v[196:199], v249 offset:2048
    ds_read_b128 v[200:203], v249 offset:3072
    ds_read_b128 v[204:207], v250 offset:0
    ds_read_b128 v[208:211], v250 offset:1024
    ds_read_b128 v[212:215], v250 offset:2048
    ds_read_b128 v[216:219], v250 offset:3072
    v_add_u32 v49, 71680, v49
    v_add_u32 v248, 71680, v248
    v_add_u32 v249, 71680, v249
    v_add_u32 v250, 71680, v250
    s_waitcnt lgkmcnt(0)
    s_waitcnt vmcnt(11)
    v_mfma_f32_16x16x32_bf16 a[192:195], a[32:35], a[136:139], a[192:195]
    ds_write_b128 v49, a[176:179] offset:0
    v_mfma_f32_16x16x32_bf16 a[196:199], a[36:39], a[136:139], a[196:199]
    v_add_f32 v60, v60, v172
    v_add_f32 v61, v61, v173
    v_add_f32 v62, v62, v174
    v_mfma_f32_16x16x32_bf16 a[200:203], a[40:43], a[136:139], a[200:203]
    v_add_f32 v63, v63, v175
    v_add_f32 v64, v64, v176
    v_add_f32 v65, v65, v177
    v_mfma_f32_16x16x32_bf16 a[204:207], a[44:47], a[136:139], a[204:207]
    s_add_u32 s53, s27, 16384
    buffer_load_dwordx4 a[136:139], v51, s[40:43], s53 offen sc1
    s_waitcnt vmcnt(11)
    v_mfma_f32_16x16x32_bf16 a[192:195], a[48:51], a[140:143], a[192:195]
    ds_write_b128 v49, a[180:183] offset:1024
    v_mfma_f32_16x16x32_bf16 a[196:199], a[52:55], a[140:143], a[196:199]
    v_add_f32 v66, v66, v178
    v_add_f32 v67, v67, v179
    v_add_f32 v68, v68, v180
    v_mfma_f32_16x16x32_bf16 a[200:203], a[56:59], a[140:143], a[200:203]
    v_add_f32 v69, v69, v181
    v_add_f32 v70, v70, v182
    v_add_f32 v71, v71, v183
    v_mfma_f32_16x16x32_bf16 a[204:207], a[60:63], a[140:143], a[204:207]
    s_add_u32 s53, s27, 20480
    buffer_load_dwordx4 a[140:143], v51, s[40:43], s53 offen sc1
    s_waitcnt vmcnt(11)
    v_mfma_f32_16x16x32_bf16 a[192:195], a[64:67], a[144:147], a[192:195]
    ds_write_b128 v49, a[184:187] offset:2048
    v_mfma_f32_16x16x32_bf16 a[196:199], a[68:71], a[144:147], a[196:199]
    v_add_f32 v72, v72, v184
    v_add_f32 v73, v73, v185
    v_add_f32 v74, v74, v186
    v_mfma_f32_16x16x32_bf16 a[200:203], a[72:75], a[144:147], a[200:203]
    v_add_f32 v75, v75, v187
    v_add_f32 v60, v60, v188
    v_add_f32 v61, v61, v189
    v_mfma_f32_16x16x32_bf16 a[204:207], a[76:79], a[144:147], a[204:207]
    s_add_u32 s53, s27, 24576
    buffer_load_dwordx4 a[144:147], v51, s[40:43], s53 offen sc1
    s_waitcnt vmcnt(11)
    v_mfma_f32_16x16x32_bf16 a[192:195], a[80:83], a[148:151], a[192:195]
    ds_write_b128 v49, a[188:191] offset:3072
    v_mfma_f32_16x16x32_bf16 a[196:199], a[84:87], a[148:151], a[196:199]
    v_add_f32 v62, v62, v190
    v_add_f32 v63, v63, v191
    v_add_f32 v64, v64, v192
    v_mfma_f32_16x16x32_bf16 a[200:203], a[88:91], a[148:151], a[200:203]
    v_add_f32 v65, v65, v193
    v_add_f32 v66, v66, v194
    v_add_f32 v67, v67, v195
    v_mfma_f32_16x16x32_bf16 a[204:207], a[92:95], a[148:151], a[204:207]
    s_add_u32 s53, s27, 45056
    buffer_load_dwordx4 a[148:151], v51, s[40:43], s53 offen sc1
    s_waitcnt vmcnt(11)
    v_mfma_f32_16x16x32_bf16 a[192:195], a[96:99], a[152:155], a[192:195]
    v_add_f32 v68, v68, v196
    v_add_f32 v69, v69, v197
    v_add_f32 v70, v70, v198
    v_mfma_f32_16x16x32_bf16 a[196:199], a[100:103], a[152:155], a[196:199]
    v_add_f32 v71, v71, v199
    v_add_f32 v72, v72, v200
    v_add_f32 v73, v73, v201
    v_mfma_f32_16x16x32_bf16 a[200:203], a[104:107], a[152:155], a[200:203]
    v_add_f32 v74, v74, v202
    v_add_f32 v75, v75, v203
    v_add_f32 v60, v60, v204
    v_mfma_f32_16x16x32_bf16 a[204:207], a[108:111], a[152:155], a[204:207]
    s_add_u32 s53, s27, 49152
    buffer_load_dwordx4 a[152:155], v51, s[40:43], s53 offen sc1
    s_waitcnt vmcnt(11)
    v_mfma_f32_16x16x32_bf16 a[192:195], a[112:115], a[156:159], a[192:195]
    v_add_f32 v61, v61, v205
    v_add_f32 v62, v62, v206
    v_add_f32 v63, v63, v207
    v_mfma_f32_16x16x32_bf16 a[196:199], a[116:119], a[156:159], a[196:199]
    v_add_f32 v64, v64, v208
    v_add_f32 v65, v65, v209
    v_add_f32 v66, v66, v210
    v_mfma_f32_16x16x32_bf16 a[200:203], a[120:123], a[156:159], a[200:203]
    v_add_f32 v67, v67, v211
    v_add_f32 v68, v68, v212
    v_add_f32 v69, v69, v213
    v_mfma_f32_16x16x32_bf16 a[204:207], a[124:127], a[156:159], a[204:207]
    s_add_u32 s53, s27, 53248
    buffer_load_dwordx4 a[156:159], v51, s[40:43], s53 offen sc1
    s_waitcnt vmcnt(11)
    v_mfma_f32_16x16x32_bf16 a[208:211], a[32:35], a[160:163], a[208:211]
    ds_write_b128 v49, a[192:195] offset:4096
    v_mfma_f32_16x16x32_bf16 a[212:215], a[36:39], a[160:163], a[212:215]
    v_add_f32 v70, v70, v214
    v_add_f32 v71, v71, v215
    v_add_f32 v72, v72, v216
    v_mfma_f32_16x16x32_bf16 a[216:219], a[40:43], a[160:163], a[216:219]
    v_add_f32 v73, v73, v217
    v_add_f32 v74, v74, v218
    v_add_f32 v75, v75, v219
    v_mfma_f32_16x16x32_bf16 a[220:223], a[44:47], a[160:163], a[220:223]
    v_lshlrev_b32 v220, 16, v20
    v_and_b32 v221, 0xffff0000, v20
    v_lshlrev_b32 v222, 16, v21
    s_waitcnt vmcnt(10)
    v_mfma_f32_16x16x32_bf16 a[208:211], a[48:51], a[164:167], a[208:211]
    ds_write_b128 v49, a[196:199] offset:5120
    v_mfma_f32_16x16x32_bf16 a[212:215], a[52:55], a[164:167], a[212:215]
    v_and_b32 v223, 0xffff0000, v21
    v_lshlrev_b32 v224, 16, v22
    v_and_b32 v225, 0xffff0000, v22
    v_mfma_f32_16x16x32_bf16 a[216:219], a[56:59], a[164:167], a[216:219]
    v_lshlrev_b32 v226, 16, v23
    v_and_b32 v227, 0xffff0000, v23
    v_lshlrev_b32 v228, 16, v24
    v_mfma_f32_16x16x32_bf16 a[220:223], a[60:63], a[164:167], a[220:223]
    v_and_b32 v229, 0xffff0000, v24
    v_lshlrev_b32 v230, 16, v25
    v_and_b32 v231, 0xffff0000, v25
    s_waitcnt vmcnt(9)
    v_mfma_f32_16x16x32_bf16 a[208:211], a[64:67], a[168:171], a[208:211]
    ds_write_b128 v49, a[200:203] offset:6144
    v_mfma_f32_16x16x32_bf16 a[212:215], a[68:71], a[168:171], a[212:215]
    v_lshlrev_b32 v232, 16, v26
    v_and_b32 v233, 0xffff0000, v26
    v_lshlrev_b32 v234, 16, v27
    v_mfma_f32_16x16x32_bf16 a[216:219], a[72:75], a[168:171], a[216:219]
    v_and_b32 v235, 0xffff0000, v27
    v_mfma_f32_16x16x32_bf16 a[220:223], a[76:79], a[168:171], a[220:223]
    s_waitcnt vmcnt(8)
    v_mfma_f32_16x16x32_bf16 a[208:211], a[80:83], a[172:175], a[208:211]
    ds_write_b128 v49, a[204:207] offset:7168
    v_mfma_f32_16x16x32_bf16 a[212:215], a[84:87], a[172:175], a[212:215]
    v_mfma_f32_16x16x32_bf16 a[216:219], a[88:91], a[172:175], a[216:219]
    v_mfma_f32_16x16x32_bf16 a[220:223], a[92:95], a[172:175], a[220:223]
    s_waitcnt vmcnt(7)
    v_mfma_f32_16x16x32_bf16 a[208:211], a[96:99], a[128:131], a[208:211]
    v_mfma_f32_16x16x32_bf16 a[212:215], a[100:103], a[128:131], a[212:215]
    v_mfma_f32_16x16x32_bf16 a[216:219], a[104:107], a[128:131], a[216:219]
    v_mfma_f32_16x16x32_bf16 a[220:223], a[108:111], a[128:131], a[220:223]
    s_waitcnt vmcnt(6)
    v_mfma_f32_16x16x32_bf16 a[208:211], a[112:115], a[132:135], a[208:211]
    v_mfma_f32_16x16x32_bf16 a[212:215], a[116:119], a[132:135], a[212:215]
    v_mfma_f32_16x16x32_bf16 a[216:219], a[120:123], a[132:135], a[216:219]
    v_mfma_f32_16x16x32_bf16 a[220:223], a[124:127], a[132:135], a[220:223]
    s_waitcnt vmcnt(5)
    v_mfma_f32_16x16x32_bf16 v[28:31], a[32:35], a[136:139], v[28:31]
    s_nop 2
    ds_write_b128 v49, a[208:211] offset:8192
    v_mfma_f32_16x16x32_bf16 v[32:35], a[36:39], a[136:139], v[32:35]
    v_mfma_f32_16x16x32_bf16 v[36:39], a[40:43], a[136:139], v[36:39]
    v_mfma_f32_16x16x32_bf16 v[40:43], a[44:47], a[136:139], v[40:43]
    s_waitcnt vmcnt(4)
    v_mfma_f32_16x16x32_bf16 v[28:31], a[48:51], a[140:143], v[28:31]
    ds_write_b128 v49, a[212:215] offset:9216
    v_mfma_f32_16x16x32_bf16 v[32:35], a[52:55], a[140:143], v[32:35]
    v_mfma_f32_16x16x32_bf16 v[36:39], a[56:59], a[140:143], v[36:39]
    v_mfma_f32_16x16x32_bf16 v[40:43], a[60:63], a[140:143], v[40:43]
    s_waitcnt vmcnt(3)
    v_mfma_f32_16x16x32_bf16 v[28:31], a[64:67], a[144:147], v[28:31]
    ds_write_b128 v49, a[216:219] offset:10240
    v_mfma_f32_16x16x32_bf16 v[32:35], a[68:71], a[144:147], v[32:35]
    v_mfma_f32_16x16x32_bf16 v[36:39], a[72:75], a[144:147], v[36:39]
    v_mfma_f32_16x16x32_bf16 v[40:43], a[76:79], a[144:147], v[40:43]
    s_waitcnt vmcnt(2)
    v_mfma_f32_16x16x32_bf16 v[28:31], a[80:83], a[148:151], v[28:31]
    ds_write_b128 v49, a[220:223] offset:11264
    v_mfma_f32_16x16x32_bf16 v[32:35], a[84:87], a[148:151], v[32:35]
    v_mfma_f32_16x16x32_bf16 v[36:39], a[88:91], a[148:151], v[36:39]
    v_mfma_f32_16x16x32_bf16 v[40:43], a[92:95], a[148:151], v[40:43]
    s_waitcnt lgkmcnt(0)
    s_barrier
    s_waitcnt vmcnt(1)
    v_mfma_f32_16x16x32_bf16 v[28:31], a[96:99], a[152:155], v[28:31]
    ds_read_b128 v[172:175], v248 offset:0
    ds_read_b128 v[176:179], v248 offset:1024
    ds_read_b128 v[180:183], v248 offset:2048
    v_mfma_f32_16x16x32_bf16 v[32:35], a[100:103], a[152:155], v[32:35]
    ds_read_b128 v[184:187], v248 offset:3072
    ds_read_b128 v[188:191], v249 offset:0
    ds_read_b128 v[192:195], v249 offset:1024
    v_mfma_f32_16x16x32_bf16 v[36:39], a[104:107], a[152:155], v[36:39]
    ds_read_b128 v[196:199], v249 offset:2048
    ds_read_b128 v[200:203], v249 offset:3072
    ds_read_b128 v[204:207], v250 offset:0
    v_mfma_f32_16x16x32_bf16 v[40:43], a[108:111], a[152:155], v[40:43]
    ds_read_b128 v[208:211], v250 offset:1024
    ds_read_b128 v[212:215], v250 offset:2048
    ds_read_b128 v[216:219], v250 offset:3072
    s_waitcnt vmcnt(0)
    v_mfma_f32_16x16x32_bf16 v[28:31], a[112:115], a[156:159], v[28:31]
    s_mov_b32 s58, 0xbfb8aa3b
    s_mov_b32 s59, s58
    v_lshl_add_u32 v12, v10, 10, v58
    v_mfma_f32_16x16x32_bf16 v[32:35], a[116:119], a[156:159], v[32:35]
    v_mfma_f32_16x16x32_bf16 v[36:39], a[120:123], a[156:159], v[36:39]
    v_mfma_f32_16x16x32_bf16 v[40:43], a[124:127], a[156:159], v[40:43]
    s_waitcnt lgkmcnt(7)
    v_pk_add_f32 v[172:173], v[172:173], v[188:189]
    v_pk_add_f32 v[174:175], v[174:175], v[190:191]
    s_waitcnt lgkmcnt(6)
    v_pk_add_f32 v[176:177], v[176:177], v[192:193]
    v_pk_add_f32 v[178:179], v[178:179], v[194:195]
    s_waitcnt lgkmcnt(3)
    v_pk_add_f32 v[28:29], v[28:29], v[204:205]
    v_pk_add_f32 v[30:31], v[30:31], v[206:207]
    s_waitcnt lgkmcnt(2)
    v_pk_add_f32 v[32:33], v[32:33], v[208:209]
    v_pk_add_f32 v[34:35], v[34:35], v[210:211]
    v_pk_add_f32 v[28:29], v[28:29], v[172:173]
    v_pk_add_f32 v[30:31], v[30:31], v[174:175]
    v_pk_add_f32 v[32:33], v[32:33], v[176:177]
    v_pk_add_f32 v[34:35], v[34:35], v[178:179]
    v_pk_mul_f32 v[92:93], v[28:29], s[58:59]
    v_pk_mul_f32 v[94:95], v[30:31], s[58:59]
    v_pk_mul_f32 v[96:97], v[32:33], s[58:59]
    v_pk_mul_f32 v[98:99], v[34:35], s[58:59]
    v_pk_mul_f32 v[60:61], v[60:61], v[28:29]
    v_pk_mul_f32 v[62:63], v[62:63], v[30:31]
    v_pk_mul_f32 v[64:65], v[64:65], v[32:33]
    v_pk_mul_f32 v[66:67], v[66:67], v[34:35]
    v_exp_f32 v92, v92
    v_exp_f32 v94, v94
    v_exp_f32 v96, v96
    v_exp_f32 v98, v98
    v_exp_f32 v93, v93
    v_exp_f32 v95, v95
    v_exp_f32 v97, v97
    v_exp_f32 v99, v99
    v_pk_add_f32 v[92:93], v[92:93], 1.0 op_sel_hi:[1,0]
    v_pk_add_f32 v[94:95], v[94:95], 1.0 op_sel_hi:[1,0]
    v_pk_add_f32 v[96:97], v[96:97], 1.0 op_sel_hi:[1,0]
    v_pk_add_f32 v[98:99], v[98:99], 1.0 op_sel_hi:[1,0]
    v_rcp_f32 v92, v92
    v_rcp_f32 v94, v94
    v_rcp_f32 v96, v96
    v_rcp_f32 v98, v98
    v_rcp_f32 v93, v93
    v_rcp_f32 v95, v95
    v_rcp_f32 v97, v97
    v_rcp_f32 v99, v99
    v_pk_fma_f32 v[28:29], v[60:61], v[92:93], v[220:221]
    v_pk_fma_f32 v[30:31], v[62:63], v[94:95], v[222:223]
    v_pk_fma_f32 v[32:33], v[64:65], v[96:97], v[224:225]
    v_pk_fma_f32 v[34:35], v[66:67], v[98:99], v[226:227]
    v_cvt_pk_bf16_f32 v76, v28, v29
    v_cvt_pk_bf16_f32 v77, v30, v31
    v_cvt_pk_bf16_f32 v78, v32, v33
    v_cvt_pk_bf16_f32 v79, v34, v35
    s_nop 0
    v_permlane16_swap_b32 v76, v78
    v_permlane16_swap_b32 v77, v79
    buffer_store_dwordx4 v[76:79], v12, s[36:39], s73 offen offset:0
    v_pk_add_f32 v[180:181], v[180:181], v[196:197]
    v_pk_add_f32 v[182:183], v[182:183], v[198:199]
    v_pk_add_f32 v[184:185], v[184:185], v[200:201]
    v_pk_add_f32 v[186:187], v[186:187], v[202:203]
    s_waitcnt lgkmcnt(1)
    v_pk_add_f32 v[36:37], v[36:37], v[212:213]
    v_pk_add_f32 v[38:39], v[38:39], v[214:215]
    s_waitcnt lgkmcnt(0)
    v_pk_add_f32 v[40:41], v[40:41], v[216:217]
    v_pk_add_f32 v[42:43], v[42:43], v[218:219]
    v_pk_add_f32 v[36:37], v[36:37], v[180:181]
    v_pk_add_f32 v[38:39], v[38:39], v[182:183]
    v_pk_add_f32 v[40:41], v[40:41], v[184:185]
    v_pk_add_f32 v[42:43], v[42:43], v[186:187]
    v_pk_mul_f32 v[100:101], v[36:37], s[58:59]
    v_pk_mul_f32 v[102:103], v[38:39], s[58:59]
    v_pk_mul_f32 v[104:105], v[40:41], s[58:59]
    v_pk_mul_f32 v[106:107], v[42:43], s[58:59]
    v_pk_mul_f32 v[68:69], v[68:69], v[36:37]
    v_pk_mul_f32 v[70:71], v[70:71], v[38:39]
    v_pk_mul_f32 v[72:73], v[72:73], v[40:41]
    v_pk_mul_f32 v[74:75], v[74:75], v[42:43]
    v_exp_f32 v100, v100
    v_exp_f32 v102, v102
    v_exp_f32 v104, v104
    v_exp_f32 v106, v106
    v_exp_f32 v101, v101
    v_exp_f32 v103, v103
    v_exp_f32 v105, v105
    v_exp_f32 v107, v107
    v_pk_add_f32 v[100:101], v[100:101], 1.0 op_sel_hi:[1,0]
    v_pk_add_f32 v[102:103], v[102:103], 1.0 op_sel_hi:[1,0]
    v_pk_add_f32 v[104:105], v[104:105], 1.0 op_sel_hi:[1,0]
    v_pk_add_f32 v[106:107], v[106:107], 1.0 op_sel_hi:[1,0]
    v_rcp_f32 v100, v100
    v_rcp_f32 v102, v102
    v_rcp_f32 v104, v104
    v_rcp_f32 v106, v106
    v_rcp_f32 v101, v101
    v_rcp_f32 v103, v103
    v_rcp_f32 v105, v105
    v_rcp_f32 v107, v107
    v_pk_fma_f32 v[36:37], v[68:69], v[100:101], v[228:229]
    v_pk_fma_f32 v[38:39], v[70:71], v[102:103], v[230:231]
    v_pk_fma_f32 v[40:41], v[72:73], v[104:105], v[232:233]
    v_pk_fma_f32 v[42:43], v[74:75], v[106:107], v[234:235]
    v_cvt_pk_bf16_f32 v80, v36, v37
    v_cvt_pk_bf16_f32 v81, v38, v39
    v_cvt_pk_bf16_f32 v82, v40, v41
    v_cvt_pk_bf16_f32 v83, v42, v43
    s_nop 0
    v_permlane16_swap_b32 v80, v82
    v_permlane16_swap_b32 v81, v83
    buffer_store_dwordx4 v[80:83], v12, s[36:39], s73 offen offset:64
Lend:
    s_endpgm
Lcode_end:

.section .rodata,"a"
.p2align 6
.amdhsa_kernel recurrent_scan__spectral_gfnet__mixer_s_mlp__prompt_kernel
  .amdhsa_next_free_vgpr 512
  .amdhsa_next_free_sgpr 102
  .amdhsa_accum_offset 256
  .amdhsa_group_segment_fixed_size 0
  .amdhsa_kernarg_size 88
  .amdhsa_user_sgpr_count 2
  .amdhsa_user_sgpr_kernarg_segment_ptr 1
  .amdhsa_system_sgpr_workgroup_id_x 1
.end_amdhsa_kernel
```
